```python
import torch

def _softmax(x, axis=-1):
    return torch.softmax(x, dim=axis)
def _gelu(x):
    return torch.nn.functional.gelu(x, approximate="tanh")
def _silu(x):
    return torch.nn.functional.silu(x)
def _sigmoid(x):
    return torch.sigmoid(x)
def _layernorm(x, axis=-1, eps=1e-5):
    m = x.mean(dim=axis, keepdim=True)
    v = x.var(dim=axis, keepdim=True, unbiased=False)
    return (x - m) / torch.sqrt(v + eps)
def _scatter_add(tgt, idx, src, axis=0):
    return tgt.clone().index_add_(axis, idx, src)
def _segment_sum(src, seg, n):
    out = torch.zeros((n,) + src.shape[1:], dtype=src.dtype)
    return out.index_add_(0, seg, src)
def _pad(x, pw):
    flat = tuple(v for pair in reversed(pw) for v in pair)
    return torch.nn.functional.pad(x, flat)

kernel_name = 'sequential_preLN__ssm_conv_s4d__glu_gated_geglu__prompt'

def setup_inputs():

    _w = (lambda a: (lambda t: t.to(torch.bfloat16) if t.is_floating_point() else t)(torch.as_tensor(a)))
    def _A_setup():
        Bsz, L, D, N = 1, 2048, 512, 128
        return {
            "u": _w((lambda *s: torch.randn(*s, dtype=torch.bfloat16) * 0.05)(Bsz, L, D)),
            "log_A_real": _w((lambda *s: torch.randn(*s, dtype=torch.bfloat16) * 6.4)(D, N) * 0.5),
            "A_imag": _w((lambda *s: torch.randn(*s, dtype=torch.bfloat16) * 0.05)(D, N) * 3.14),
            "C_real": _w((lambda *s: torch.randn(*s, dtype=torch.bfloat16) * 0.05)(D, N) / N ** 0.5),
            "C_imag": _w((lambda *s: torch.randn(*s, dtype=torch.bfloat16) * 0.05)(D, N) / N ** 0.5),
            "log_dt": _w((lambda *s: torch.randn(*s, dtype=torch.bfloat16) * 0.05)(D) * 0.5 - 4.0),
            "D_skip": _w((lambda *s: torch.randn(*s, dtype=torch.bfloat16) * 0.05)(D)),
        }
    _A_in = _A_setup()

    def _B_setup():
        B, S, Dm, Df = 1, 2048, 512, 1376
        return {
            "x": _w((lambda *s: torch.randn(*s, dtype=torch.bfloat16) * 0.05)(B, S, Dm)),
            "w_gate": _w((lambda *s: torch.randn(*s, dtype=torch.bfloat16) * 0.4)(Dm, Df) * (Dm ** -0.5)),
            "w_up": _w((lambda *s: torch.randn(*s, dtype=torch.bfloat16) * 0.4)(Dm, Df) * (Dm ** -0.5)),
            "w_down": _w((lambda *s: torch.randn(*s, dtype=torch.bfloat16) * 0.4)(Df, Dm) * (Df ** -0.5)),
        }
    _B_in = _B_setup()

    return {
        "A_u": _A_in["u"],
        "A_log_A_real": _A_in["log_A_real"],
        "A_A_imag": _A_in["A_imag"],
        "A_C_real": _A_in["C_real"],
        "A_C_imag": _A_in["C_imag"],
        "A_log_dt": _A_in["log_dt"],
        "A_D_skip": _A_in["D_skip"],
        "B_x": _B_in["x"],
        "B_w_gate": _B_in["w_gate"],
        "B_w_up": _B_in["w_up"],
        "B_w_down": _B_in["w_down"],
    }

def reference(A_u, A_log_A_real, A_A_imag, A_C_real, A_C_imag, A_log_dt, A_D_skip, B_x, B_w_gate, B_w_up, B_w_down):
    def _A_ref(u, log_A_real, A_imag, C_real, C_imag, log_dt, D_skip):
        L = u.shape[1]
        dt = torch.exp(log_dt)
        A = -torch.exp(log_A_real) + 1j * A_imag
        C = (C_real + 1j * C_imag) * dt[:, None]
        pos = (lambda x, dt: x.to(dt))(torch.arange(L), log_dt.dtype)
        P = torch.exp((A * dt[:, None])[:, :, None] * pos[None, None, :])
        K = 2.0 * torch.einsum("dn,dnl->dl", C, P).real
        L2 = 2 * L
        u_t = (lambda x, *d: x.permute(*d))(u, 0, 2, 1)
        Kf = (lambda x, *a, **k: torch.fft.rfft(x.float(), *a, **k))(K, L2)
        Uf = (lambda x, *a, **k: torch.fft.rfft(x.float(), *a, **k))(u_t, L2)
        y = (lambda x, *a, **k: torch.fft.irfft(x, *a, **k).to(torch.bfloat16))(Uf * Kf[None, :, :], L2)[:, :, :L]
        y = (lambda x, *d: x.permute(*d))(y, 0, 2, 1)
        return y + u * D_skip[None, None, :]

    def _B_ref(x, w_gate, w_up, w_down):
        g = torch.einsum("bsd,df->bsf", x, w_gate)
        u = torch.einsum("bsd,df->bsf", x, w_up)
        h = _gelu(g) * u
        return torch.einsum("bsf,fd->bsd", h, w_down)

    x = A_u
    h = x + _A_ref(_layernorm(x, axis=-1), A_log_A_real, A_A_imag, A_C_real, A_C_imag, A_log_dt, A_D_skip)
    h2 = h + _B_ref(_layernorm(h, axis=-1), B_w_gate, B_w_up, B_w_down)
    return h2
```

```asm
; @launch grid=(256,1,1) block=(512,1,1) lds=163840
.amdgcn_target "amdgcn-amd-amdhsa--gfx950"
.text
.globl sequential_preLN__ssm_conv_s4d__glu_gated_geglu__prompt_kernel
.p2align 8
.type sequential_preLN__ssm_conv_s4d__glu_gated_geglu__prompt_kernel,@function
sequential_preLN__ssm_conv_s4d__glu_gated_geglu__prompt_kernel:
    s_load_dwordx16 s[4:19], s[0:1], 0
    s_load_dwordx2 s[28:29], s[0:1], 104
    s_load_dwordx8 s[20:27], s[0:1], 64
    s_cmp_ge_u32 s2, 256
    s_cbranch_scc1 L_END
    v_lshrrev_b32 v1, 6, v0
    s_nop 0
    v_readfirstlane_b32 s3, v1
    v_and_b32 v1, 63, v0
    s_and_b32 s31, s2, 7
    s_lshl_b32 s31, s31, 5
    s_lshr_b32 s32, s2, 3
    s_add_u32 s31, s31, s32
    s_lshl_b32 s33, s31, 2
    v_mov_b32 v200, 58624
    s_cmp_lt_u32 s3, 4
    s_cbranch_scc1 L_A
    s_cmp_lg_u32 s3, 7
    s_cbranch_scc1 L_NOCODE
    s_getpc_b64 s[36:37]
L_PC:
    v_and_b32 v2, 7, v1
    s_lshl_b32 s38, s32, 3
    v_add_u32 v2, s38, v2
    v_min_u32 v2, (CODE_END-L_PC)/128, v2
    v_lshlrev_b32_e64 v2, 7, v2
    global_load_dword v201, v2, s[36:37]
L_NOCODE:
    v_subrev_u32 v2, 256, v0
    v_lshrrev_b32 v6, 3, v1
    v_and_b32 v7, 7, v1
    v_lshlrev_b32_e64 v9, 10, v6
    v_lshl_add_u32 v9, v7, 4, v9
    s_lshl_b32 s36, s31, 13
    v_add_u32 v9, s36, v9
    v_mov_b32 v8, 0
    ds_write2_b32 v200, v8, v8 offset0:0 offset1:2
    ds_write2_b32 v200, v8, v8 offset0:4 offset1:6
    v_lshlrev_b32 v12, 2, v2
    v_and_b32 v12, 0x1fc, v12
    v_bfe_u32 v10, v2, 7, 1
    v_mul_u32_u24 v10, 4608, v10
    v_add_u32 v12, v12, v10
    ds_write_b32 v12, v8 offset:49408
    v_and_b32 v12, 31, v2
    v_min_u32 v12, 16, v12
    v_lshlrev_b32 v12, 2, v12
    v_bfe_u32 v10, v2, 5, 2
    v_mul_u32_u24 v10, 4160, v10
    v_add_u32 v12, v12, v10
    ds_write_b32 v12, v8 offset:36860
    v_lshlrev_b32 v4, 13, v7
    v_lshl_add_u32 v4, v6, 4, v4
    s_lshl_b32 s36, s32, 16
    s_and_b32 s37, s3, 3
    s_lshl_b32 s38, s37, 11
    s_add_u32 s36, s36, s38
    s_and_b32 s38, s2, 7
    s_lshl_b32 s39, s38, 7
    s_add_u32 s36, s36, s39
    v_add_u32 v4, s36, v4
    s_cmp_lg_u32 s3, 5
    s_waitcnt lgkmcnt(0)
    s_load_dword s30, s[28:29], 126976
    s_cbranch_scc1 L_NOROWS
    global_load_dwordx4 v[128:131], v9, s[4:5] offset:0
    global_load_dwordx4 v[132:135], v9, s[4:5] offset:128
    global_load_dwordx4 v[136:139], v9, s[4:5] offset:256
    global_load_dwordx4 v[140:143], v9, s[4:5] offset:384
    global_load_dwordx4 v[144:147], v9, s[4:5] offset:512
    global_load_dwordx4 v[148:151], v9, s[4:5] offset:640
    global_load_dwordx4 v[152:155], v9, s[4:5] offset:768
    global_load_dwordx4 v[156:159], v9, s[4:5] offset:896
L_NOROWS:
    global_load_dwordx4 v[100:103], v4, s[4:5]
    global_load_dwordx4 v[104:107], v4, s[4:5] offset:1024
    s_load_dword s57, s[16:17], s33
    s_branch L_B
L_A:
    s_setprio 2
    s_lshr_b32 s34, s3, 1
    s_and_b32 s35, s3, 1
    s_lshl_b32 s36, s31, 9
    v_lshl_add_u32 v9, v0, 1, s36
    s_waitcnt lgkmcnt(0)
    global_load_ushort v4, v9, s[6:7]
    global_load_ushort v5, v9, s[8:9]
    global_load_ushort v6, v9, s[10:11]
    global_load_ushort v7, v9, s[12:13]
    s_load_dword s56, s[14:15], s33
    s_barrier
    s_mov_b32 s48, s28
    s_mov_b32 s49, s29
    s_mov_b32 s50, 0x78000
    s_mov_b32 s51, 0x20000
    s_add_u32 s52, s28, 0x600000
    s_addc_u32 s53, s29, 0
    s_mov_b32 s54, 0x400000
    s_mov_b32 s55, 0x20000
    s_and_b32 s13, s2, 7
    s_lshl_b32 s8, s13, 2
    s_lshr_b32 s18, s32, 3
    s_add_u32 s8, s8, s18
    s_and_b32 s9, s32, 7
    s_and_b32 s6, s13, 6
    s_lshl_b32 s6, s6, 1
    s_and_b32 s18, s32, 3
    s_add_u32 s6, s6, s18
    s_lshl_b32 s10, s13, 1
    s_lshr_b32 s18, s32, 2
    s_and_b32 s13, s13, 1
    s_mul_i32 s7, s13, 7
    s_add_u32 s7, s7, s18
    s_sub_u32 s13, 15, s13
    s_cmp_eq_u32 s18, 7
    s_cselect_b32 s7, s13, s7
    s_and_b32 s11, s3, 3
    v_and_b32 v8, 31, v0
    v_bfe_u32 v9, v0, 2, 5
    v_mul_u32_u24 v9, 1040, v9
    v_and_b32_e64 v10, 3, v0
    v_lshl_add_u32 v9, v10, 2, v9
    s_mul_i32 s60, s34, 33280
    s_add_u32 s60, s60, 65536
    v_add_u32 v9, s60, v9
    s_cmp_eq_u32 s35, 0
    s_mov_b32 s66, 0x111
    s_cselect_b32 s62, 0x1234567, s66
    s_cselect_b32 s63, 0x122234, s66
    s_cselect_b32 s64, 0x11122, s66
    s_mov_b32 s66, 0x19171513
    s_cselect_b32 s65, 0x100d0800, s66
    v_bfe_u32 v10, v1, 3, 2
    v_and_b32 v11, 7, v1
    v_mov_b32 v12, s64
    v_mov_b32 v13, s63
    v_mov_b32 v14, s62
    v_cmp_eq_u32 vcc, 1, v10
    s_nop 1
    v_cndmask_b32 v12, v12, v13, vcc
    v_cmp_eq_u32 vcc, 0, v10
    s_nop 1
    v_cndmask_b32 v12, v12, v14, vcc
    v_lshlrev_b32 v11, 2, v11
    v_lshrrev_b32 v12, v11, v12
    v_and_b32 v12, 15, v12
    v_lshlrev_b32 v10, 3, v10
    v_lshrrev_b32 v13, v10, s65
    v_and_b32 v13, 0xff, v13
    v_add3_u32 v12, v12, v13, 32
    v_lshrrev_b32_e64 v13, 5, v1
    v_mul_u32_u24 v13, 1040, v13
    v_add_u32_e64 v13, s60, v13
    v_lshl_add_u32 v164, v12, 4, v13
    v_lshl_add_u32 v165, v8, 4, v13
    v_lshrrev_b32 v11, 5, v1
    v_lshlrev_b32 v12, 3, v11
    v_lshlrev_b32 v13, 4, v8
    v_sub_u32 v12, v12, v13
    s_mul_i32 s62, s34, 8320
    s_lshl_b32 s63, s35, 11
    s_sub_u32 s63, s62, s63
    s_add_u32 s63, s63, 35312
    v_add_u32 v176, s63, v12
    v_and_b32 v13, 33, v1
    s_sub_u32 s63, 2, s35
    v_cmp_eq_u32 s[58:59], s63, v13
    v_and_b32 v10, 15, v1
    v_lshrrev_b32 v11, 4, v1
    v_lshlrev_b32 v14, 3, v11
    v_sub_u32 v14, v14, v10
    v_lshlrev_b32 v14, 1, v14
    v_and_b32 v13, 1, v10
    v_xor_b32 v13, 1, v13
    v_mul_u32_u24 v13, 4158, v13
    v_add_u32 v14, v14, v13
    s_lshl_b32 s63, s35, 8
    s_sub_u32 s62, s62, s63
    s_add_u32 s64, s62, 36126
    v_add_u32 v170, s64, v14
    s_add_u32 s64, s62, 35102
    v_add_u32 v171, s64, v14
    s_add_u32 s64, s62, 34078
    v_add_u32 v172, s64, v14
    s_add_u32 s64, s62, 33054
    v_add_u32 v173, s64, v14
    v_lshlrev_b32 v3, 5, v10
    v_lshl_add_u32 v3, v11, 4, v3
    s_mul_i32 s64, s34, 4608
    s_sub_u32 s64, s64, s63
    s_add_u32 s64, s64, 49696
    v_add_u32 v174, s64, v3
    v_lshrrev_b32 v2, 2, v1
    v_and_b32 v2, 8, v2
    v_xor_b32 v2, v2, v1
    v_lshlrev_b32 v2, 4, v2
    s_lshl_b32 s64, s3, 13
    v_add_u32 v175, s64, v2
    v_mov_b32 v178, 1
    s_waitcnt lgkmcnt(0)
    s_lshl_b32 s61, s34, 4
    s_lshr_b32 s61, s56, s61
    s_lshl_b32 s61, s61, 16
    v_mov_b32 v10, s61
    v_mul_f32 v11, 0x3fb8aa00, v10
    v_mul_f32 v12, 0x36a407db, v10
    v_exp_f32 v11, v11
    s_nop 0
    v_fma_f32 v11, v11, v12, v11
    v_cvt_pk_bf16_f32 v11, v11, v11
    v_lshlrev_b32 v11, 16, v11
    s_waitcnt vmcnt(0)
    v_lshlrev_b32 v4, 16, v4
    v_lshlrev_b32 v5, 16, v5
    v_lshlrev_b32 v6, 16, v6
    v_lshlrev_b32 v7, 16, v7
    v_mul_f32 v12, 0x3fb8aa00, v4
    v_mul_f32 v13, 0x36a407db, v4
    v_exp_f32 v12, v12
    s_nop 0
    v_fma_f32 v12, v12, v13, v12
    v_cvt_pk_bf16_f32 v12, v12, v12
    v_lshlrev_b32 v12, 16, v12
    v_mul_f32 v12, v12, v11
    v_mul_f32 v12, 0xbfb8aa3b, v12
    v_mul_f32_e64 v5, v5, v11
    v_mul_f32 v13, 0x3e230000, v5
    v_mul_f32 v14, 0xb7cf9236, v5
    v_add_f32 v11, v11, v11
    v_mul_f32 v96, v6, v11
    v_mul_f32_e64 v97, v7, v11
    v_mul_f32 v15, 0x41000000, v12
    v_mul_f32 v16, 0x41000000, v13
    v_exp_f32 v15, v15
    v_fract_f32 v16, v16
    v_fmac_f32 v16, 0x41000000, v14
    v_cos_f32 v26, v16
    v_sin_f32 v27, v16
    s_nop 0
    v_pk_mul_f32 v[26:27], v[26:27], v[14:15] op_sel:[0,1] op_sel_hi:[1,1]
    v_mul_f32 v15, 0x42800000, v12
    v_mul_f32 v16, 0x42800000, v13
    v_exp_f32 v15, v15
    v_fract_f32_e64 v16, v16
    v_fmac_f32 v16, 0x42800000, v14
    v_cos_f32 v40, v16
    v_sin_f32 v41, v16
    s_nop 0
    v_pk_mul_f32 v[40:41], v[40:41], v[14:15] op_sel:[0,1] op_sel_hi:[1,1]
    v_mul_f32 v15, 0x3f800000, v12
    v_mul_f32 v16, 0x3f800000, v13
    v_exp_f32 v15, v15
    v_fract_f32 v16, v16
    v_fmac_f32 v16, 0x3f800000, v14
    v_cos_f32 v18, v16
    v_sin_f32 v19, v16
    s_nop 0
    v_pk_mul_f32 v[18:19], v[18:19], v[14:15] op_sel:[0,1] op_sel_hi:[1,1]
    v_mul_f32 v15, 0x43800000, v12
    v_mul_f32 v16, 0x43800000, v13
    v_exp_f32 v15, v15
    v_fract_f32_e64 v16, v16
    v_fmac_f32 v16, 0x43800000, v14
    v_cos_f32 v90, v16
    v_sin_f32 v91, v16
    s_nop 0
    s_nop 0
    v_pk_mul_f32 v[90:91], v[90:91], v[14:15] op_sel:[0,1] op_sel_hi:[1,1]
    v_pk_mul_f32 v[28:29], v[26:27], v[26:27] op_sel:[0,0] op_sel_hi:[0,1]
    v_pk_fma_f32 v[28:29], v[26:27], v[26:27], v[28:29] op_sel:[1,1,0] op_sel_hi:[1,0,1] neg_lo:[1,0,0]
    v_pk_mul_f32 v[56:57], v[40:41], v[40:41] op_sel:[0,0] op_sel_hi:[0,1]
    v_pk_fma_f32 v[56:57], v[40:41], v[40:41], v[56:57] op_sel:[1,1,0] op_sel_hi:[1,0,1] neg_lo:[1,0,0]
    v_pk_mul_f32 v[92:93], v[18:19], v[18:19] op_sel:[0,0] op_sel_hi:[0,1]
    v_pk_fma_f32 v[92:93], v[18:19], v[18:19], v[92:93] op_sel:[1,1,0] op_sel_hi:[1,0,1] neg_lo:[1,0,0]
    v_pk_mul_f32 v[112:113], v[96:97], v[90:91] op_sel:[0,0] op_sel_hi:[0,1]
    v_pk_fma_f32 v[112:113], v[96:97], v[90:91], v[112:113] op_sel:[1,1,0] op_sel_hi:[1,0,1] neg_lo:[1,0,0]
    v_pk_mul_f32 v[30:31], v[28:29], v[26:27] op_sel:[0,0] op_sel_hi:[0,1]
    v_pk_fma_f32 v[30:31], v[28:29], v[26:27], v[30:31] op_sel:[1,1,0] op_sel_hi:[1,0,1] neg_lo:[1,0,0]
    v_pk_mul_f32 v[32:33], v[28:29], v[28:29] op_sel:[0,0] op_sel_hi:[0,1]
    v_pk_fma_f32 v[32:33], v[28:29], v[28:29], v[32:33] op_sel:[1,1,0] op_sel_hi:[1,0,1] neg_lo:[1,0,0]
    v_pk_mul_f32 v[72:73], v[56:57], v[40:41] op_sel:[0,0] op_sel_hi:[0,1]
    v_pk_fma_f32 v[72:73], v[56:57], v[40:41], v[72:73] op_sel:[1,1,0] op_sel_hi:[1,0,1] neg_lo:[1,0,0]
    v_pk_mul_f32 v[22:23], v[92:93], v[92:93] op_sel:[0,0] op_sel_hi:[0,1]
    v_pk_fma_f32 v[22:23], v[92:93], v[92:93], v[22:23] op_sel:[1,1,0] op_sel_hi:[1,0,1] neg_lo:[1,0,0]
    v_pk_mul_f32 v[122:123], v[112:113], v[90:91] op_sel:[0,0] op_sel_hi:[0,1]
    v_pk_fma_f32 v[122:123], v[112:113], v[90:91], v[122:123] op_sel:[1,1,0] op_sel_hi:[1,0,1] neg_lo:[1,0,0]
    v_pk_mul_f32 v[98:99], v[96:97], v[18:19] op_sel:[0,0] op_sel_hi:[0,1]
    v_pk_fma_f32 v[98:99], v[96:97], v[18:19], v[98:99] op_sel:[1,1,0] op_sel_hi:[1,0,1] neg_lo:[1,0,0]
    v_pk_mul_f32 v[100:101], v[96:97], v[92:93] op_sel:[0,0] op_sel_hi:[0,1]
    v_pk_fma_f32 v[100:101], v[96:97], v[92:93], v[100:101] op_sel:[1,1,0] op_sel_hi:[1,0,1] neg_lo:[1,0,0]
    v_pk_mul_f32 v[34:35], v[32:33], v[26:27] op_sel:[0,0] op_sel_hi:[0,1]
    v_pk_fma_f32 v[34:35], v[32:33], v[26:27], v[34:35] op_sel:[1,1,0] op_sel_hi:[1,0,1] neg_lo:[1,0,0]
    v_pk_mul_f32 v[36:37], v[32:33], v[28:29] op_sel:[0,0] op_sel_hi:[0,1]
    v_pk_fma_f32 v[36:37], v[32:33], v[28:29], v[36:37] op_sel:[1,1,0] op_sel_hi:[1,0,1] neg_lo:[1,0,0]
    v_pk_mul_f32 v[38:39], v[32:33], v[30:31] op_sel:[0,0] op_sel_hi:[0,1]
    v_pk_fma_f32 v[38:39], v[32:33], v[30:31], v[38:39] op_sel:[1,1,0] op_sel_hi:[1,0,1] neg_lo:[1,0,0]
    v_pk_mul_f32 v[128:129], v[122:123], v[90:91] op_sel:[0,0] op_sel_hi:[0,1]
    v_pk_fma_f32 v[128:129], v[122:123], v[90:91], v[128:129] op_sel:[1,1,0] op_sel_hi:[1,0,1] neg_lo:[1,0,0]
    v_pk_mul_f32 v[102:103], v[98:99], v[92:93] op_sel:[0,0] op_sel_hi:[0,1]
    v_pk_fma_f32 v[102:103], v[98:99], v[92:93], v[102:103] op_sel:[1,1,0] op_sel_hi:[1,0,1] neg_lo:[1,0,0]
    v_pk_mul_f32 v[104:105], v[96:97], v[22:23] op_sel:[0,0] op_sel_hi:[0,1]
    v_pk_fma_f32 v[104:105], v[96:97], v[22:23], v[104:105] op_sel:[1,1,0] op_sel_hi:[1,0,1] neg_lo:[1,0,0]
    v_pk_mul_f32 v[106:107], v[98:99], v[22:23] op_sel:[0,0] op_sel_hi:[0,1]
    v_pk_fma_f32 v[106:107], v[98:99], v[22:23], v[106:107] op_sel:[1,1,0] op_sel_hi:[1,0,1] neg_lo:[1,0,0]
    v_pk_mul_f32 v[108:109], v[100:101], v[22:23] op_sel:[0,0] op_sel_hi:[0,1]
    v_pk_fma_f32 v[108:109], v[100:101], v[22:23], v[108:109] op_sel:[1,1,0] op_sel_hi:[1,0,1] neg_lo:[1,0,0]
    v_pk_mul_f32 v[134:135], v[128:129], v[90:91] op_sel:[0,0] op_sel_hi:[0,1]
    v_pk_fma_f32 v[134:135], v[128:129], v[90:91], v[134:135] op_sel:[1,1,0] op_sel_hi:[1,0,1] neg_lo:[1,0,0]
    v_pk_mul_f32 v[110:111], v[102:103], v[22:23] op_sel:[0,0] op_sel_hi:[0,1]
    v_pk_fma_f32 v[110:111], v[102:103], v[22:23], v[110:111] op_sel:[1,1,0] op_sel_hi:[1,0,1] neg_lo:[1,0,0]
    v_pk_mul_f32 v[114:115], v[112:113], v[92:93] op_sel:[0,0] op_sel_hi:[0,1]
    v_pk_fma_f32 v[114:115], v[112:113], v[92:93], v[114:115] op_sel:[1,1,0] op_sel_hi:[1,0,1] neg_lo:[1,0,0]
    v_pk_mul_f32 v[116:117], v[112:113], v[22:23] op_sel:[0,0] op_sel_hi:[0,1]
    v_pk_fma_f32 v[116:117], v[112:113], v[22:23], v[116:117] op_sel:[1,1,0] op_sel_hi:[1,0,1] neg_lo:[1,0,0]
    v_pk_mul_f32 v[120:121], v[112:113], v[26:27] op_sel:[0,0] op_sel_hi:[0,1]
    v_pk_fma_f32 v[120:121], v[112:113], v[26:27], v[120:121] op_sel:[1,1,0] op_sel_hi:[1,0,1] neg_lo:[1,0,0]
    v_pk_mul_f32 v[138:139], v[134:135], v[90:91] op_sel:[0,0] op_sel_hi:[0,1]
    v_pk_fma_f32 v[138:139], v[134:135], v[90:91], v[138:139] op_sel:[1,1,0] op_sel_hi:[1,0,1] neg_lo:[1,0,0]
    v_pk_mul_f32 v[118:119], v[114:115], v[22:23] op_sel:[0,0] op_sel_hi:[0,1]
    v_pk_fma_f32 v[118:119], v[114:115], v[22:23], v[118:119] op_sel:[1,1,0] op_sel_hi:[1,0,1] neg_lo:[1,0,0]
    v_pk_mul_f32 v[124:125], v[122:123], v[22:23] op_sel:[0,0] op_sel_hi:[0,1]
    v_pk_fma_f32 v[124:125], v[122:123], v[22:23], v[124:125] op_sel:[1,1,0] op_sel_hi:[1,0,1] neg_lo:[1,0,0]
    v_pk_mul_f32 v[126:127], v[122:123], v[26:27] op_sel:[0,0] op_sel_hi:[0,1]
    v_pk_fma_f32 v[126:127], v[122:123], v[26:27], v[126:127] op_sel:[1,1,0] op_sel_hi:[1,0,1] neg_lo:[1,0,0]
    v_pk_mul_f32 v[142:143], v[138:139], v[90:91] op_sel:[0,0] op_sel_hi:[0,1]
    v_pk_fma_f32 v[142:143], v[138:139], v[90:91], v[142:143] op_sel:[1,1,0] op_sel_hi:[1,0,1] neg_lo:[1,0,0]
    v_pk_mul_f32 v[130:131], v[128:129], v[22:23] op_sel:[0,0] op_sel_hi:[0,1]
    v_pk_fma_f32 v[130:131], v[128:129], v[22:23], v[130:131] op_sel:[1,1,0] op_sel_hi:[1,0,1] neg_lo:[1,0,0]
    v_pk_mul_f32 v[132:133], v[128:129], v[26:27] op_sel:[0,0] op_sel_hi:[0,1]
    v_pk_fma_f32 v[132:133], v[128:129], v[26:27], v[132:133] op_sel:[1,1,0] op_sel_hi:[1,0,1] neg_lo:[1,0,0]
    v_pk_mul_f32 v[136:137], v[134:135], v[26:27] op_sel:[0,0] op_sel_hi:[0,1]
    v_pk_fma_f32 v[136:137], v[134:135], v[26:27], v[136:137] op_sel:[1,1,0] op_sel_hi:[1,0,1] neg_lo:[1,0,0]
    v_pk_mul_f32 v[146:147], v[142:143], v[90:91] op_sel:[0,0] op_sel_hi:[0,1]
    v_pk_fma_f32 v[146:147], v[142:143], v[90:91], v[146:147] op_sel:[1,1,0] op_sel_hi:[1,0,1] neg_lo:[1,0,0]
    v_pk_mul_f32 v[140:141], v[138:139], v[26:27] op_sel:[0,0] op_sel_hi:[0,1]
    v_pk_fma_f32 v[140:141], v[138:139], v[26:27], v[140:141] op_sel:[1,1,0] op_sel_hi:[1,0,1] neg_lo:[1,0,0]
    v_pk_mul_f32 v[144:145], v[142:143], v[26:27] op_sel:[0,0] op_sel_hi:[0,1]
    v_pk_fma_f32 v[144:145], v[142:143], v[26:27], v[144:145] op_sel:[1,1,0] op_sel_hi:[1,0,1] neg_lo:[1,0,0]
    v_pk_mul_f32 v[148:149], v[146:147], v[26:27] op_sel:[0,0] op_sel_hi:[0,1]
    v_pk_fma_f32 v[148:149], v[146:147], v[26:27], v[148:149] op_sel:[1,1,0] op_sel_hi:[1,0,1] neg_lo:[1,0,0]
    v_cvt_pk_bf16_f32 v96, v96, -v97
    v_cvt_pk_bf16_f32 v98, v98, -v99
    ds_write2_b32 v9, v96, v98 offset0:128 offset1:132
    v_cvt_pk_bf16_f32 v100, v100, -v101
    v_cvt_pk_bf16_f32 v102, v102, -v103
    ds_write2_b32 v9, v100, v102 offset0:136 offset1:140
    v_cvt_pk_bf16_f32 v104, v104, -v105
    v_cvt_pk_bf16_f32 v106, v106, -v107
    ds_write2_b32 v9, v104, v106 offset0:144 offset1:148
    v_cvt_pk_bf16_f32 v108, v108, -v109
    v_cvt_pk_bf16_f32 v110, v110, -v111
    ds_write2_b32 v9, v108, v110 offset0:152 offset1:156
    v_cvt_pk_bf16_f32 v112, v112, -v113
    v_cvt_pk_bf16_f32 v114, v114, -v115
    ds_write2_b32 v9, v112, v114 offset0:160 offset1:164
    v_cvt_pk_bf16_f32 v116, v116, -v117
    v_cvt_pk_bf16_f32 v118, v118, -v119
    ds_write2_b32 v9, v116, v118 offset0:168 offset1:172
    v_cvt_pk_bf16_f32 v120, v120, -v121
    v_cvt_pk_bf16_f32 v122, v122, -v123
    ds_write2_b32 v9, v120, v122 offset0:176 offset1:180
    v_cvt_pk_bf16_f32 v124, v124, -v125
    v_cvt_pk_bf16_f32 v126, v126, -v127
    ds_write2_b32 v9, v124, v126 offset0:184 offset1:188
    v_cvt_pk_bf16_f32 v128, v128, -v129
    v_cvt_pk_bf16_f32 v130, v130, -v131
    ds_write2_b32 v9, v128, v130 offset0:192 offset1:196
    v_cvt_pk_bf16_f32 v132, v132, -v133
    v_cvt_pk_bf16_f32 v134, v134, -v135
    ds_write2_b32 v9, v132, v134 offset0:200 offset1:204
    v_cvt_pk_bf16_f32 v136, v136, -v137
    v_cvt_pk_bf16_f32 v138, v138, -v139
    ds_write2_b32 v9, v136, v138 offset0:208 offset1:212
    v_cvt_pk_bf16_f32 v140, v140, -v141
    v_cvt_pk_bf16_f32 v142, v142, -v143
    ds_write2_b32 v9, v140, v142 offset0:216 offset1:220
    v_cvt_pk_bf16_f32 v144, v144, -v145
    v_cvt_pk_bf16_f32 v146, v146, -v147
    ds_write2_b32 v9, v144, v146 offset0:224 offset1:228
    v_cvt_pk_bf16_f32 v148, v148, -v149
    v_mov_b32 v24, 0x3f80
    ds_write2_b32 v9, v148, v24 offset0:232 offset1:0
    v_pk_mul_f32 v[42:43], v[40:41], v[26:27] op_sel:[0,0] op_sel_hi:[0,1]
    v_pk_fma_f32 v[42:43], v[40:41], v[26:27], v[42:43] op_sel:[1,1,0] op_sel_hi:[1,0,1] neg_lo:[1,0,0]
    v_pk_mul_f32 v[44:45], v[40:41], v[28:29] op_sel:[0,0] op_sel_hi:[0,1]
    v_pk_fma_f32 v[44:45], v[40:41], v[28:29], v[44:45] op_sel:[1,1,0] op_sel_hi:[1,0,1] neg_lo:[1,0,0]
    v_pk_mul_f32 v[46:47], v[40:41], v[30:31] op_sel:[0,0] op_sel_hi:[0,1]
    v_pk_fma_f32 v[46:47], v[40:41], v[30:31], v[46:47] op_sel:[1,1,0] op_sel_hi:[1,0,1] neg_lo:[1,0,0]
    v_pk_mul_f32 v[48:49], v[40:41], v[32:33] op_sel:[0,0] op_sel_hi:[0,1]
    v_pk_fma_f32 v[48:49], v[40:41], v[32:33], v[48:49] op_sel:[1,1,0] op_sel_hi:[1,0,1] neg_lo:[1,0,0]
    v_pk_mul_f32 v[50:51], v[40:41], v[34:35] op_sel:[0,0] op_sel_hi:[0,1]
    v_pk_fma_f32 v[50:51], v[40:41], v[34:35], v[50:51] op_sel:[1,1,0] op_sel_hi:[1,0,1] neg_lo:[1,0,0]
    v_pk_mul_f32 v[52:53], v[40:41], v[36:37] op_sel:[0,0] op_sel_hi:[0,1]
    v_pk_fma_f32 v[52:53], v[40:41], v[36:37], v[52:53] op_sel:[1,1,0] op_sel_hi:[1,0,1] neg_lo:[1,0,0]
    v_pk_mul_f32 v[54:55], v[40:41], v[38:39] op_sel:[0,0] op_sel_hi:[0,1]
    v_pk_fma_f32 v[54:55], v[40:41], v[38:39], v[54:55] op_sel:[1,1,0] op_sel_hi:[1,0,1] neg_lo:[1,0,0]
    v_cvt_pk_bf16_f32 v40, v40, v41
    v_cvt_pk_bf16_f32 v42, v42, v43
    ds_write2_b32 v9, v40, v42 offset0:32 offset1:36
    v_cvt_pk_bf16_f32 v44, v44, v45
    v_cvt_pk_bf16_f32 v46, v46, v47
    ds_write2_b32 v9, v44, v46 offset0:40 offset1:44
    v_cvt_pk_bf16_f32 v48, v48, v49
    v_cvt_pk_bf16_f32 v50, v50, v51
    ds_write2_b32 v9, v48, v50 offset0:48 offset1:52
    v_cvt_pk_bf16_f32 v52, v52, v53
    v_cvt_pk_bf16_f32 v54, v54, v55
    ds_write2_b32 v9, v52, v54 offset0:56 offset1:60
    v_pk_mul_f32 v[58:59], v[56:57], v[26:27] op_sel:[0,0] op_sel_hi:[0,1]
    v_pk_fma_f32 v[58:59], v[56:57], v[26:27], v[58:59] op_sel:[1,1,0] op_sel_hi:[1,0,1] neg_lo:[1,0,0]
    v_pk_mul_f32 v[60:61], v[56:57], v[28:29] op_sel:[0,0] op_sel_hi:[0,1]
    v_pk_fma_f32 v[60:61], v[56:57], v[28:29], v[60:61] op_sel:[1,1,0] op_sel_hi:[1,0,1] neg_lo:[1,0,0]
    v_pk_mul_f32 v[62:63], v[56:57], v[30:31] op_sel:[0,0] op_sel_hi:[0,1]
    v_pk_fma_f32 v[62:63], v[56:57], v[30:31], v[62:63] op_sel:[1,1,0] op_sel_hi:[1,0,1] neg_lo:[1,0,0]
    v_pk_mul_f32 v[64:65], v[56:57], v[32:33] op_sel:[0,0] op_sel_hi:[0,1]
    v_pk_fma_f32 v[64:65], v[56:57], v[32:33], v[64:65] op_sel:[1,1,0] op_sel_hi:[1,0,1] neg_lo:[1,0,0]
    v_pk_mul_f32 v[66:67], v[56:57], v[34:35] op_sel:[0,0] op_sel_hi:[0,1]
    v_pk_fma_f32 v[66:67], v[56:57], v[34:35], v[66:67] op_sel:[1,1,0] op_sel_hi:[1,0,1] neg_lo:[1,0,0]
    v_pk_mul_f32 v[68:69], v[56:57], v[36:37] op_sel:[0,0] op_sel_hi:[0,1]
    v_pk_fma_f32 v[68:69], v[56:57], v[36:37], v[68:69] op_sel:[1,1,0] op_sel_hi:[1,0,1] neg_lo:[1,0,0]
    v_pk_mul_f32 v[70:71], v[56:57], v[38:39] op_sel:[0,0] op_sel_hi:[0,1]
    v_pk_fma_f32 v[70:71], v[56:57], v[38:39], v[70:71] op_sel:[1,1,0] op_sel_hi:[1,0,1] neg_lo:[1,0,0]
    v_cvt_pk_bf16_f32 v56, v56, v57
    v_cvt_pk_bf16_f32 v58, v58, v59
    ds_write2_b32 v9, v56, v58 offset0:64 offset1:68
    v_cvt_pk_bf16_f32 v60, v60, v61
    v_cvt_pk_bf16_f32 v62, v62, v63
    ds_write2_b32 v9, v60, v62 offset0:72 offset1:76
    v_cvt_pk_bf16_f32 v64, v64, v65
    v_cvt_pk_bf16_f32 v66, v66, v67
    ds_write2_b32 v9, v64, v66 offset0:80 offset1:84
    v_cvt_pk_bf16_f32 v68, v68, v69
    v_cvt_pk_bf16_f32 v70, v70, v71
    ds_write2_b32 v9, v68, v70 offset0:88 offset1:92
    v_pk_mul_f32 v[74:75], v[72:73], v[26:27] op_sel:[0,0] op_sel_hi:[0,1]
    v_pk_fma_f32 v[74:75], v[72:73], v[26:27], v[74:75] op_sel:[1,1,0] op_sel_hi:[1,0,1] neg_lo:[1,0,0]
    v_pk_mul_f32 v[76:77], v[72:73], v[28:29] op_sel:[0,0] op_sel_hi:[0,1]
    v_pk_fma_f32 v[76:77], v[72:73], v[28:29], v[76:77] op_sel:[1,1,0] op_sel_hi:[1,0,1] neg_lo:[1,0,0]
    v_pk_mul_f32 v[78:79], v[72:73], v[30:31] op_sel:[0,0] op_sel_hi:[0,1]
    v_pk_fma_f32 v[78:79], v[72:73], v[30:31], v[78:79] op_sel:[1,1,0] op_sel_hi:[1,0,1] neg_lo:[1,0,0]
    v_pk_mul_f32 v[80:81], v[72:73], v[32:33] op_sel:[0,0] op_sel_hi:[0,1]
    v_pk_fma_f32 v[80:81], v[72:73], v[32:33], v[80:81] op_sel:[1,1,0] op_sel_hi:[1,0,1] neg_lo:[1,0,0]
    v_pk_mul_f32 v[82:83], v[72:73], v[34:35] op_sel:[0,0] op_sel_hi:[0,1]
    v_pk_fma_f32 v[82:83], v[72:73], v[34:35], v[82:83] op_sel:[1,1,0] op_sel_hi:[1,0,1] neg_lo:[1,0,0]
    v_pk_mul_f32 v[84:85], v[72:73], v[36:37] op_sel:[0,0] op_sel_hi:[0,1]
    v_pk_fma_f32 v[84:85], v[72:73], v[36:37], v[84:85] op_sel:[1,1,0] op_sel_hi:[1,0,1] neg_lo:[1,0,0]
    v_pk_mul_f32 v[86:87], v[72:73], v[38:39] op_sel:[0,0] op_sel_hi:[0,1]
    v_pk_fma_f32 v[86:87], v[72:73], v[38:39], v[86:87] op_sel:[1,1,0] op_sel_hi:[1,0,1] neg_lo:[1,0,0]
    v_cvt_pk_bf16_f32 v72, v72, v73
    v_cvt_pk_bf16_f32 v74, v74, v75
    ds_write2_b32 v9, v72, v74 offset0:96 offset1:100
    v_cvt_pk_bf16_f32 v76, v76, v77
    v_cvt_pk_bf16_f32 v78, v78, v79
    ds_write2_b32 v9, v76, v78 offset0:104 offset1:108
    v_cvt_pk_bf16_f32 v80, v80, v81
    v_cvt_pk_bf16_f32 v82, v82, v83
    ds_write2_b32 v9, v80, v82 offset0:112 offset1:116
    v_cvt_pk_bf16_f32 v84, v84, v85
    v_cvt_pk_bf16_f32 v86, v86, v87
    ds_write2_b32 v9, v84, v86 offset0:120 offset1:124
    v_cvt_pk_bf16_f32 v26, v26, v27
    v_cvt_pk_bf16_f32 v28, v28, v29
    v_cvt_pk_bf16_f32 v30, v30, v31
    v_cvt_pk_bf16_f32 v32, v32, v33
    v_cvt_pk_bf16_f32 v34, v34, v35
    v_cvt_pk_bf16_f32 v36, v36, v37
    v_cvt_pk_bf16_f32 v38, v38, v39
    ds_write2_b32 v9, v26, v28 offset0:4 offset1:8
    ds_write2_b32 v9, v30, v32 offset0:12 offset1:16
    ds_write2_b32 v9, v34, v36 offset0:20 offset1:24
    ds_write_b32 v9, v38 offset:112
    s_waitcnt lgkmcnt(0)
    s_mov_b64 exec, 1
    ds_add_u32 v200, v178 offset:8
    s_mov_b64 exec, -1
L_TABWAIT:
    ds_read_b64 v[2:3], v200 offset:8
    s_waitcnt lgkmcnt(0)
    v_readfirstlane_b32 s61, v2
    s_nop 0
    s_cmp_lt_u32 s61, 5
    s_cbranch_scc1 L_TABWAIT
    v_readfirstlane_b32 s30, v3
    ds_read_b128 v[16:19], v164 offset:0
    ds_read_b128 v[80:83], v165 offset:0
    ds_read_b128 v[20:23], v164 offset:2080
    ds_read_b128 v[84:87], v165 offset:2080
    ds_read_b128 v[24:27], v164 offset:4160
    ds_read_b128 v[88:91], v165 offset:4160
    ds_read_b128 v[28:31], v164 offset:6240
    ds_read_b128 v[92:95], v165 offset:6240
    ds_read_b128 v[32:35], v164 offset:8320
    ds_read_b128 v[96:99], v165 offset:8320
    s_waitcnt lgkmcnt(8)
    v_mfma_f32_32x32x16_bf16 v[144:159], v[16:19], v[80:83], 0
    ds_read_b128 v[36:39], v164 offset:10400
    ds_read_b128 v[100:103], v165 offset:10400
    s_waitcnt lgkmcnt(8)
    v_mfma_f32_32x32x16_bf16 v[144:159], v[20:23], v[84:87], v[144:159]
    ds_read_b128 v[40:43], v164 offset:12480
    ds_read_b128 v[104:107], v165 offset:12480
    s_waitcnt lgkmcnt(8)
    v_mfma_f32_32x32x16_bf16 v[144:159], v[24:27], v[88:91], v[144:159]
    ds_read_b128 v[44:47], v164 offset:14560
    ds_read_b128 v[108:111], v165 offset:14560
    s_waitcnt lgkmcnt(8)
    v_mfma_f32_32x32x16_bf16 v[144:159], v[28:31], v[92:95], v[144:159]
    ds_read_b128 v[48:51], v164 offset:16640
    ds_read_b128 v[112:115], v165 offset:16640
    s_waitcnt lgkmcnt(8)
    v_mfma_f32_32x32x16_bf16 v[144:159], v[32:35], v[96:99], v[144:159]
    ds_read_b128 v[52:55], v164 offset:18720
    ds_read_b128 v[116:119], v165 offset:18720
    s_waitcnt lgkmcnt(8)
    v_mfma_f32_32x32x16_bf16 v[144:159], v[36:39], v[100:103], v[144:159]
    ds_read_b128 v[56:59], v164 offset:20800
    ds_read_b128 v[120:123], v165 offset:20800
    s_waitcnt lgkmcnt(8)
    v_mfma_f32_32x32x16_bf16 v[144:159], v[40:43], v[104:107], v[144:159]
    ds_read_b128 v[60:63], v164 offset:22880
    ds_read_b128 v[124:127], v165 offset:22880
    s_waitcnt lgkmcnt(8)
    v_mfma_f32_32x32x16_bf16 v[144:159], v[44:47], v[108:111], v[144:159]
    ds_read_b128 v[64:67], v164 offset:24960
    ds_read_b128 v[128:131], v165 offset:24960
    s_waitcnt lgkmcnt(8)
    v_mfma_f32_32x32x16_bf16 v[144:159], v[48:51], v[112:115], v[144:159]
    ds_read_b128 v[68:71], v164 offset:27040
    ds_read_b128 v[132:135], v165 offset:27040
    s_waitcnt lgkmcnt(8)
    v_mfma_f32_32x32x16_bf16 v[144:159], v[52:55], v[116:119], v[144:159]
    ds_read_b128 v[72:75], v164 offset:29120
    ds_read_b128 v[136:139], v165 offset:29120
    s_waitcnt lgkmcnt(8)
    v_mfma_f32_32x32x16_bf16 v[144:159], v[56:59], v[120:123], v[144:159]
    ds_read_b128 v[76:79], v164 offset:31200
    ds_read_b128 v[140:143], v165 offset:31200
    s_waitcnt lgkmcnt(8)
    v_mfma_f32_32x32x16_bf16 v[144:159], v[60:63], v[124:127], v[144:159]
    s_waitcnt lgkmcnt(6)
    v_mfma_f32_32x32x16_bf16 v[144:159], v[64:67], v[128:131], v[144:159]
    s_waitcnt lgkmcnt(4)
    v_mfma_f32_32x32x16_bf16 v[144:159], v[68:71], v[132:135], v[144:159]
    s_waitcnt lgkmcnt(2)
    v_mfma_f32_32x32x16_bf16 v[144:159], v[72:75], v[136:139], v[144:159]
    s_waitcnt lgkmcnt(0)
    v_mfma_f32_32x32x16_bf16 v[144:159], v[76:79], v[140:143], v[144:159]
    s_mov_b32 s19, 65536
    s_nop 10
    v_cndmask_b32 v147, v147, v146, s[58:59]
    v_cvt_pk_bf16_f32 v16, v144, v145
    v_cvt_pk_bf16_f32 v17, v146, v147
    v_cvt_pk_bf16_f32 v18, v145, v146
    ds_write_b64 v176, v[16:17] offset:1536
    ds_write_b16 v176, v16 offset:5694
    ds_write_b32 v176, v18 offset:5696
    ds_write_b16_d16_hi v176, v17 offset:5700
    v_cndmask_b32 v151, v151, v150, s[58:59]
    v_cvt_pk_bf16_f32 v20, v148, v149
    v_cvt_pk_bf16_f32 v21, v150, v151
    v_cvt_pk_bf16_f32 v22, v149, v150
    ds_write_b64 v176, v[20:21] offset:1024
    ds_write_b16 v176, v20 offset:5182
    ds_write_b32 v176, v22 offset:5184
    ds_write_b16_d16_hi v176, v21 offset:5188
    v_cndmask_b32 v155, v155, v154, s[58:59]
    v_cvt_pk_bf16_f32 v24, v152, v153
    v_cvt_pk_bf16_f32 v25, v154, v155
    v_cvt_pk_bf16_f32 v26, v153, v154
    ds_write_b64 v176, v[24:25] offset:512
    ds_write_b16 v176, v24 offset:4670
    ds_write_b32 v176, v26 offset:4672
    ds_write_b16_d16_hi v176, v25 offset:4676
    v_cndmask_b32 v159, v159, v158, s[58:59]
    v_cvt_pk_bf16_f32 v28, v156, v157
    v_cvt_pk_bf16_f32 v29, v158, v159
    v_cvt_pk_bf16_f32 v30, v157, v158
    ds_write_b64 v176, v[28:29] offset:0
    ds_write_b16 v176, v28 offset:4158
    ds_write_b32 v176, v30 offset:4160
    ds_write_b16_d16_hi v176, v29 offset:4164
    s_waitcnt lgkmcnt(0)
    s_mov_b64 exec, 1
    ds_add_u32 v200, v178 offset:16
    s_mov_b64 exec, -1
L_KWAIT:
    ds_read_b64 v[2:3], v200 offset:16
    s_waitcnt lgkmcnt(0)
    v_readfirstlane_b32 s61, v2
    s_nop 0
    s_cmp_lt_u32 s61, 4
    s_cbranch_scc1 L_KWAIT
    ds_read2_b32 v[16:17], v170 offset0:176 offset1:177
    ds_read2_b32 v[18:19], v170 offset0:178 offset1:179
    ds_read2_b32 v[20:21], v170 offset0:48 offset1:49
    ds_read2_b32 v[22:23], v170 offset0:50 offset1:51
    ds_read2_b32 v[24:25], v171 offset0:176 offset1:177
    ds_read2_b32 v[26:27], v171 offset0:178 offset1:179
    ds_read2_b32 v[28:29], v171 offset0:48 offset1:49
    ds_read2_b32 v[30:31], v171 offset0:50 offset1:51
    ds_read2_b32 v[32:33], v172 offset0:176 offset1:177
    ds_read2_b32 v[34:35], v172 offset0:178 offset1:179
    ds_read2_b32 v[36:37], v172 offset0:48 offset1:49
    ds_read2_b32 v[38:39], v172 offset0:50 offset1:51
    ds_read2_b32 v[40:41], v173 offset0:176 offset1:177
    ds_read2_b32 v[42:43], v173 offset0:178 offset1:179
    ds_read2_b32 v[44:45], v173 offset0:48 offset1:49
    ds_read2_b32 v[46:47], v173 offset0:50 offset1:51
    ds_read2_b32 v[80:81], v170 offset0:160 offset1:161
    ds_read2_b32 v[82:83], v170 offset0:162 offset1:163
    ds_read2_b32 v[84:85], v170 offset0:32 offset1:33
    ds_read2_b32 v[86:87], v170 offset0:34 offset1:35
    ds_read2_b32 v[88:89], v171 offset0:160 offset1:161
    ds_read2_b32 v[90:91], v171 offset0:162 offset1:163
    ds_read2_b32 v[92:93], v171 offset0:32 offset1:33
    ds_read2_b32 v[94:95], v171 offset0:34 offset1:35
    ds_read2_b32 v[96:97], v172 offset0:160 offset1:161
    ds_read2_b32 v[98:99], v172 offset0:162 offset1:163
    ds_read2_b32 v[100:101], v172 offset0:32 offset1:33
    ds_read2_b32 v[102:103], v172 offset0:34 offset1:35
    ds_read2_b32 v[104:105], v173 offset0:160 offset1:161
    ds_read2_b32 v[106:107], v173 offset0:162 offset1:163
    ds_read2_b32 v[108:109], v173 offset0:32 offset1:33
    ds_read2_b32 v[110:111], v173 offset0:34 offset1:35
    v_bfe_u32 v2, v1, 4, 1
    v_lshrrev_b32_e64 v3, 5, v1
    v_bfe_u32 v4, v1, 2, 2
    v_and_b32 v5, 3, v1
    v_lshlrev_b32 v6, 4, v1
    v_and_b32 v7, 0x30, v1
    v_lshlrev_b32 v7, 2, v7
    v_xor_b32_e64 v7, v7, v6
    v_and_b32 v7, 0x1ff, v7
    v_lshrrev_b32 v8, 3, v1
    v_lshlrev_b32 v9, 2, v2
    v_and_b32 v14, 7, v1
    v_xor_b32 v9, v9, v14
    v_lshlrev_b32_e64 v9, 4, v9
    v_lshl_add_u32 v13, v8, 10, v9
    s_lshl_b32 s64, s9, 7
    v_add_u32 v13, s64, v13
    s_lshl_b32 s64, s9, 5
    s_lshl_b32 s67, s11, 3
    s_add_u32 s64, s64, s67
    s_and_b32 s67, s3, 4
    s_add_u32 s64, s64, s67
    v_lshrrev_b32 v9, 4, v1
    v_add_u32 v9, s64, v9
    v_and_b32 v8, 1, v8
    v_lshlrev_b32_e64 v8, 8, v8
    v_lshl_add_u32 v8, v14, 4, v8
    v_lshl_add_u32 v8, v9, 14, v8
    s_lshr_b32 s64, s8, 1
    v_add_u32 v9, s64, v9
    v_and_b32_e64 v9, 15, v9
    v_lshl_add_u32 v9, v9, 9, v8
    s_and_b32 s67, s8, 1
    s_lshl_b32 s67, s67, 7
    v_add_u32 v9, s67, v9
    s_mov_b32 s36, s24
    s_mov_b32 s37, s25
    s_mov_b32 s38, 0x158000
    s_mov_b32 s39, 0x20000
    s_add_u32 s44, s28, 0x78000
    s_addc_u32 s45, s29, 0
    s_mov_b32 s46, 0x988000
    s_mov_b32 s47, 0x20000
    v_lshrrev_b32_e64 v10, 2, v1
    v_mul_u32_u24 v11, 192, v10
    v_lshl_add_u32 v11, v5, 3, v11
    v_add_u32 v11, 65536, v11
    s_mul_i32 s56, s35, 3
    s_add_u32 s57, s56, 0
    v_xor_b32_e64 v12, s57, v2
    v_lshl_add_u32 v144, v12, 5, v11
    v_add_u32 v147, 49152, v144
    s_add_u32 s57, s56, 1
    v_xor_b32 v12, s57, v2
    v_lshl_add_u32 v145, v12, 5, v11
    v_add_u32 v148, 49152, v145
    s_add_u32 s57, s56, 2
    v_xor_b32 v12, s57, v2
    v_lshl_add_u32 v146, v12, 5, v11
    v_add_u32 v149, 49152, v146
    v_lshlrev_b32_e64 v11, 8, v10
    v_lshl_add_u32 v11, v5, 3, v11
    v_and_b32 v10, 7, v10
    s_lshl_b32 s56, s34, 2
    s_add_u32 s57, s56, 0
    v_xor_b32 v12, s57, v10
    v_lshl_add_u32 v150, v12, 5, v11
    s_add_u32 s57, s56, 1
    v_xor_b32 v12, s57, v10
    v_lshl_add_u32 v151, v12, 5, v11
    s_add_u32 s57, s56, 2
    v_xor_b32 v12, s57, v10
    v_lshl_add_u32 v152, v12, 5, v11
    s_add_u32 s57, s56, 3
    v_xor_b32 v12, s57, v10
    v_lshl_add_u32 v153, v12, 5, v11
    s_barrier
    ds_read_b128 v[76:79], v174 offset:3776
    ds_read_b128 v[72:75], v174 offset:3264
    ds_read_b128 v[68:71], v174 offset:2752
    ds_read_b128 v[64:67], v174 offset:2240
    ds_read_b128 v[60:63], v174 offset:1728
    ds_read_b128 v[56:59], v174 offset:1216
    ds_read_b128 v[52:55], v174 offset:704
    ds_read_b128 v[48:51], v174 offset:192
    s_waitcnt lgkmcnt(7)
    v_mfma_f32_16x16x32_bf16 v[140:143], v[16:19], v[76:79], 0
    ds_read_b128 v[76:79], v174 offset:3712
    s_waitcnt lgkmcnt(7)
    v_mfma_f32_16x16x32_bf16 v[136:139], v[16:19], v[72:75], 0
    v_mfma_f32_16x16x32_bf16 v[140:143], v[20:23], v[72:75], v[140:143]
    ds_read_b128 v[72:75], v174 offset:3200
    s_waitcnt lgkmcnt(7)
    v_mfma_f32_16x16x32_bf16 v[132:135], v[16:19], v[68:71], 0
    v_mfma_f32_16x16x32_bf16 v[136:139], v[20:23], v[68:71], v[136:139]
    v_mfma_f32_16x16x32_bf16 v[140:143], v[24:27], v[68:71], v[140:143]
    ds_read_b128 v[68:71], v174 offset:2688
    s_waitcnt lgkmcnt(7)
    v_mfma_f32_16x16x32_bf16 v[128:131], v[16:19], v[64:67], 0
    v_mfma_f32_16x16x32_bf16 v[132:135], v[20:23], v[64:67], v[132:135]
    v_mfma_f32_16x16x32_bf16 v[136:139], v[24:27], v[64:67], v[136:139]
    v_mfma_f32_16x16x32_bf16 v[140:143], v[28:31], v[64:67], v[140:143]
    ds_read_b128 v[64:67], v174 offset:2176
    s_waitcnt lgkmcnt(7)
    v_mfma_f32_16x16x32_bf16 v[124:127], v[16:19], v[60:63], 0
    v_mfma_f32_16x16x32_bf16 v[128:131], v[20:23], v[60:63], v[128:131]
    v_mfma_f32_16x16x32_bf16 v[132:135], v[24:27], v[60:63], v[132:135]
    v_mfma_f32_16x16x32_bf16 v[136:139], v[28:31], v[60:63], v[136:139]
    v_mfma_f32_16x16x32_bf16 v[140:143], v[32:35], v[60:63], v[140:143]
    ds_read_b128 v[60:63], v174 offset:1664
    s_waitcnt lgkmcnt(7)
    v_mfma_f32_16x16x32_bf16 v[120:123], v[16:19], v[56:59], 0
    v_mfma_f32_16x16x32_bf16 v[124:127], v[20:23], v[56:59], v[124:127]
    v_mfma_f32_16x16x32_bf16 v[128:131], v[24:27], v[56:59], v[128:131]
    v_mfma_f32_16x16x32_bf16 v[132:135], v[28:31], v[56:59], v[132:135]
    v_mfma_f32_16x16x32_bf16 v[136:139], v[32:35], v[56:59], v[136:139]
    v_mfma_f32_16x16x32_bf16 v[140:143], v[36:39], v[56:59], v[140:143]
    ds_read_b128 v[56:59], v174 offset:1152
    s_waitcnt lgkmcnt(7)
    v_mfma_f32_16x16x32_bf16 v[116:119], v[16:19], v[52:55], 0
    v_mfma_f32_16x16x32_bf16 v[120:123], v[20:23], v[52:55], v[120:123]
    v_mfma_f32_16x16x32_bf16 v[124:127], v[24:27], v[52:55], v[124:127]
    v_mfma_f32_16x16x32_bf16 v[128:131], v[28:31], v[52:55], v[128:131]
    v_mfma_f32_16x16x32_bf16 v[132:135], v[32:35], v[52:55], v[132:135]
    v_mfma_f32_16x16x32_bf16 v[136:139], v[36:39], v[52:55], v[136:139]
    v_mfma_f32_16x16x32_bf16 v[140:143], v[40:43], v[52:55], v[140:143]
    ds_read_b128 v[52:55], v174 offset:640
    s_waitcnt lgkmcnt(7)
    v_mfma_f32_16x16x32_bf16 v[112:115], v[16:19], v[48:51], 0
    v_mfma_f32_16x16x32_bf16 v[116:119], v[20:23], v[48:51], v[116:119]
    v_mfma_f32_16x16x32_bf16 v[120:123], v[24:27], v[48:51], v[120:123]
    v_mfma_f32_16x16x32_bf16 v[124:127], v[28:31], v[48:51], v[124:127]
    v_mfma_f32_16x16x32_bf16 v[128:131], v[32:35], v[48:51], v[128:131]
    v_mfma_f32_16x16x32_bf16 v[132:135], v[36:39], v[48:51], v[132:135]
    v_mfma_f32_16x16x32_bf16 v[136:139], v[40:43], v[48:51], v[136:139]
    v_mfma_f32_16x16x32_bf16 v[140:143], v[44:47], v[48:51], v[140:143]
    ds_read_b128 v[48:51], v174 offset:128
    s_waitcnt lgkmcnt(7)
    v_mfma_f32_16x16x32_bf16 v[140:143], v[80:83], v[76:79], v[140:143]
    ds_read_b128 v[76:79], v174 offset:3648
    s_waitcnt lgkmcnt(7)
    v_mfma_f32_16x16x32_bf16 v[136:139], v[80:83], v[72:75], v[136:139]
    ds_read2_b32 v[16:17], v170 offset0:144 offset1:145
    v_mfma_f32_16x16x32_bf16 v[140:143], v[84:87], v[72:75], v[140:143]
    ds_read_b128 v[72:75], v174 offset:3136
    s_waitcnt lgkmcnt(8)
    v_mfma_f32_16x16x32_bf16 v[132:135], v[80:83], v[68:71], v[132:135]
    ds_read2_b32 v[18:19], v170 offset0:146 offset1:147
    v_mfma_f32_16x16x32_bf16 v[136:139], v[84:87], v[68:71], v[136:139]
    ds_read2_b32 v[20:21], v170 offset0:16 offset1:17
    v_mfma_f32_16x16x32_bf16 v[140:143], v[88:91], v[68:71], v[140:143]
    ds_read_b128 v[68:71], v174 offset:2624
    s_waitcnt lgkmcnt(10)
    v_mfma_f32_16x16x32_bf16 v[128:131], v[80:83], v[64:67], v[128:131]
    ds_read2_b32 v[22:23], v170 offset0:18 offset1:19
    v_mfma_f32_16x16x32_bf16 v[132:135], v[84:87], v[64:67], v[132:135]
    ds_read2_b32 v[24:25], v171 offset0:144 offset1:145
    v_mfma_f32_16x16x32_bf16 v[136:139], v[88:91], v[64:67], v[136:139]
    ds_read2_b32 v[26:27], v171 offset0:146 offset1:147
    v_mfma_f32_16x16x32_bf16 v[140:143], v[92:95], v[64:67], v[140:143]
    ds_read_b128 v[64:67], v174 offset:2112
    s_waitcnt lgkmcnt(13)
    v_mfma_f32_16x16x32_bf16 v[124:127], v[80:83], v[60:63], v[124:127]
    ds_read2_b32 v[28:29], v171 offset0:16 offset1:17
    v_mfma_f32_16x16x32_bf16 v[128:131], v[84:87], v[60:63], v[128:131]
    ds_read2_b32 v[30:31], v171 offset0:18 offset1:19
    v_mfma_f32_16x16x32_bf16 v[132:135], v[88:91], v[60:63], v[132:135]
    ds_read2_b32 v[32:33], v172 offset0:144 offset1:145
    v_mfma_f32_16x16x32_bf16 v[136:139], v[92:95], v[60:63], v[136:139]
    ds_read2_b32 v[34:35], v172 offset0:146 offset1:147
    v_mfma_f32_16x16x32_bf16 v[140:143], v[96:99], v[60:63], v[140:143]
    ds_read_b128 v[60:63], v174 offset:1600
    s_waitcnt lgkmcnt(15)
    v_mfma_f32_16x16x32_bf16 v[120:123], v[80:83], v[56:59], v[120:123]
    ds_read2_b32 v[36:37], v172 offset0:16 offset1:17
    v_mfma_f32_16x16x32_bf16 v[124:127], v[84:87], v[56:59], v[124:127]
    ds_read2_b32 v[38:39], v172 offset0:18 offset1:19
    v_mfma_f32_16x16x32_bf16 v[128:131], v[88:91], v[56:59], v[128:131]
    ds_read2_b32 v[40:41], v173 offset0:144 offset1:145
    v_mfma_f32_16x16x32_bf16 v[132:135], v[92:95], v[56:59], v[132:135]
    ds_read2_b32 v[42:43], v173 offset0:146 offset1:147
    v_mfma_f32_16x16x32_bf16 v[136:139], v[96:99], v[56:59], v[136:139]
    ds_read2_b32 v[44:45], v173 offset0:16 offset1:17
    v_mfma_f32_16x16x32_bf16 v[140:143], v[100:103], v[56:59], v[140:143]
    ds_read_b128 v[56:59], v174 offset:1088
    v_mfma_f32_16x16x32_bf16 v[116:119], v[80:83], v[52:55], v[116:119]
    ds_read2_b32 v[46:47], v173 offset0:18 offset1:19
    v_mfma_f32_16x16x32_bf16 v[120:123], v[84:87], v[52:55], v[120:123]
    v_mfma_f32_16x16x32_bf16 v[124:127], v[88:91], v[52:55], v[124:127]
    v_mfma_f32_16x16x32_bf16 v[128:131], v[92:95], v[52:55], v[128:131]
    v_mfma_f32_16x16x32_bf16 v[132:135], v[96:99], v[52:55], v[132:135]
    v_mfma_f32_16x16x32_bf16 v[136:139], v[100:103], v[52:55], v[136:139]
    v_mfma_f32_16x16x32_bf16 v[140:143], v[104:107], v[52:55], v[140:143]
    ds_read_b128 v[52:55], v174 offset:576
    v_mfma_f32_16x16x32_bf16 v[112:115], v[80:83], v[48:51], v[112:115]
    v_mfma_f32_16x16x32_bf16 v[116:119], v[84:87], v[48:51], v[116:119]
    v_mfma_f32_16x16x32_bf16 v[120:123], v[88:91], v[48:51], v[120:123]
    v_mfma_f32_16x16x32_bf16 v[124:127], v[92:95], v[48:51], v[124:127]
    v_mfma_f32_16x16x32_bf16 v[128:131], v[96:99], v[48:51], v[128:131]
    v_mfma_f32_16x16x32_bf16 v[132:135], v[100:103], v[48:51], v[132:135]
    v_mfma_f32_16x16x32_bf16 v[136:139], v[104:107], v[48:51], v[136:139]
    v_mfma_f32_16x16x32_bf16 v[140:143], v[108:111], v[48:51], v[140:143]
    ds_read_b128 v[48:51], v174 offset:64
    s_waitcnt lgkmcnt(15)
    v_mfma_f32_16x16x32_bf16 v[140:143], v[16:19], v[76:79], v[140:143]
    ds_read_b128 v[76:79], v174 offset:3584
    v_mfma_f32_16x16x32_bf16 v[136:139], v[16:19], v[72:75], v[136:139]
    ds_read2_b32 v[80:81], v170 offset0:128 offset1:129
    v_mfma_f32_16x16x32_bf16 v[140:143], v[20:23], v[72:75], v[140:143]
    ds_read_b128 v[72:75], v174 offset:3072
    v_mfma_f32_16x16x32_bf16 v[132:135], v[16:19], v[68:71], v[132:135]
    ds_read2_b32 v[82:83], v170 offset0:130 offset1:131
    v_mfma_f32_16x16x32_bf16 v[136:139], v[20:23], v[68:71], v[136:139]
    ds_read2_b32 v[84:85], v170 offset0:0 offset1:1
    v_mfma_f32_16x16x32_bf16 v[140:143], v[24:27], v[68:71], v[140:143]
    ds_read_b128 v[68:71], v174 offset:2560
    s_waitcnt lgkmcnt(15)
    v_mfma_f32_16x16x32_bf16 v[128:131], v[16:19], v[64:67], v[128:131]
    ds_read2_b32 v[86:87], v170 offset0:2 offset1:3
    v_mfma_f32_16x16x32_bf16 v[132:135], v[20:23], v[64:67], v[132:135]
    ds_read2_b32 v[88:89], v171 offset0:128 offset1:129
    v_mfma_f32_16x16x32_bf16 v[136:139], v[24:27], v[64:67], v[136:139]
    ds_read2_b32 v[90:91], v171 offset0:130 offset1:131
    v_mfma_f32_16x16x32_bf16 v[140:143], v[28:31], v[64:67], v[140:143]
    ds_read_b128 v[64:67], v174 offset:2048
    v_mfma_f32_16x16x32_bf16 v[124:127], v[16:19], v[60:63], v[124:127]
    ds_read2_b32 v[92:93], v171 offset0:0 offset1:1
    v_mfma_f32_16x16x32_bf16 v[128:131], v[20:23], v[60:63], v[128:131]
    ds_read2_b32 v[94:95], v171 offset0:2 offset1:3
    v_mfma_f32_16x16x32_bf16 v[132:135], v[24:27], v[60:63], v[132:135]
    ds_read2_b32 v[96:97], v172 offset0:128 offset1:129
    v_mfma_f32_16x16x32_bf16 v[136:139], v[28:31], v[60:63], v[136:139]
    ds_read2_b32 v[98:99], v172 offset0:130 offset1:131
    v_mfma_f32_16x16x32_bf16 v[140:143], v[32:35], v[60:63], v[140:143]
    ds_read_b128 v[60:63], v174 offset:1536
    s_waitcnt lgkmcnt(15)
    v_mfma_f32_16x16x32_bf16 v[120:123], v[16:19], v[56:59], v[120:123]
    ds_read2_b32 v[100:101], v172 offset0:0 offset1:1
    v_mfma_f32_16x16x32_bf16 v[124:127], v[20:23], v[56:59], v[124:127]
    ds_read2_b32 v[102:103], v172 offset0:2 offset1:3
    v_mfma_f32_16x16x32_bf16 v[128:131], v[24:27], v[56:59], v[128:131]
    ds_read2_b32 v[104:105], v173 offset0:128 offset1:129
    v_mfma_f32_16x16x32_bf16 v[132:135], v[28:31], v[56:59], v[132:135]
    ds_read2_b32 v[106:107], v173 offset0:130 offset1:131
    v_mfma_f32_16x16x32_bf16 v[136:139], v[32:35], v[56:59], v[136:139]
    ds_read2_b32 v[108:109], v173 offset0:0 offset1:1
    v_mfma_f32_16x16x32_bf16 v[140:143], v[36:39], v[56:59], v[140:143]
    ds_read_b128 v[56:59], v174 offset:1024
    v_mfma_f32_16x16x32_bf16 v[116:119], v[16:19], v[52:55], v[116:119]
    ds_read2_b32 v[110:111], v173 offset0:2 offset1:3
    v_mfma_f32_16x16x32_bf16 v[120:123], v[20:23], v[52:55], v[120:123]
    v_mfma_f32_16x16x32_bf16 v[124:127], v[24:27], v[52:55], v[124:127]
    v_mfma_f32_16x16x32_bf16 v[128:131], v[28:31], v[52:55], v[128:131]
    v_mfma_f32_16x16x32_bf16 v[132:135], v[32:35], v[52:55], v[132:135]
    v_mfma_f32_16x16x32_bf16 v[136:139], v[36:39], v[52:55], v[136:139]
    v_mfma_f32_16x16x32_bf16 v[140:143], v[40:43], v[52:55], v[140:143]
    ds_read_b128 v[52:55], v174 offset:512
    v_mfma_f32_16x16x32_bf16 v[112:115], v[16:19], v[48:51], v[112:115]
    v_mfma_f32_16x16x32_bf16 v[116:119], v[20:23], v[48:51], v[116:119]
    v_mfma_f32_16x16x32_bf16 v[120:123], v[24:27], v[48:51], v[120:123]
    v_mfma_f32_16x16x32_bf16 v[124:127], v[28:31], v[48:51], v[124:127]
    v_mfma_f32_16x16x32_bf16 v[128:131], v[32:35], v[48:51], v[128:131]
    v_mfma_f32_16x16x32_bf16 v[132:135], v[36:39], v[48:51], v[132:135]
    v_mfma_f32_16x16x32_bf16 v[136:139], v[40:43], v[48:51], v[136:139]
    v_mfma_f32_16x16x32_bf16 v[140:143], v[44:47], v[48:51], v[140:143]
    ds_read_b128 v[48:51], v174 offset:0
    s_waitcnt lgkmcnt(15)
    v_mfma_f32_16x16x32_bf16 v[140:143], v[80:83], v[76:79], v[140:143]
    v_mfma_f32_16x16x32_bf16 v[140:143], v[84:87], v[72:75], v[140:143]
    v_mfma_f32_16x16x32_bf16 v[140:143], v[88:91], v[68:71], v[140:143]
    s_waitcnt lgkmcnt(12)
    v_mfma_f32_16x16x32_bf16 v[140:143], v[92:95], v[64:67], v[140:143]
    s_waitcnt lgkmcnt(9)
    v_mfma_f32_16x16x32_bf16 v[140:143], v[96:99], v[60:63], v[140:143]
    s_waitcnt lgkmcnt(3)
    v_mfma_f32_16x16x32_bf16 v[140:143], v[100:103], v[56:59], v[140:143]
    s_waitcnt lgkmcnt(1)
    v_mfma_f32_16x16x32_bf16 v[140:143], v[104:107], v[52:55], v[140:143]
    s_waitcnt lgkmcnt(0)
    v_mfma_f32_16x16x32_bf16 v[140:143], v[108:111], v[48:51], v[140:143]
    v_mfma_f32_16x16x32_bf16 v[136:139], v[80:83], v[72:75], v[136:139]
    v_mfma_f32_16x16x32_bf16 v[136:139], v[84:87], v[68:71], v[136:139]
    v_mfma_f32_16x16x32_bf16 v[136:139], v[88:91], v[64:67], v[136:139]
    v_mfma_f32_16x16x32_bf16 v[136:139], v[92:95], v[60:63], v[136:139]
    v_mfma_f32_16x16x32_bf16 v[136:139], v[96:99], v[56:59], v[136:139]
    v_mfma_f32_16x16x32_bf16 v[136:139], v[100:103], v[52:55], v[136:139]
    v_mfma_f32_16x16x32_bf16 v[136:139], v[104:107], v[48:51], v[136:139]
    v_mfma_f32_16x16x32_bf16 v[132:135], v[80:83], v[68:71], v[132:135]
    ds_write_b128 v175, v[140:143] offset:7168
    v_mfma_f32_16x16x32_bf16 v[132:135], v[84:87], v[64:67], v[132:135]
    v_mfma_f32_16x16x32_bf16 v[132:135], v[88:91], v[60:63], v[132:135]
    v_mfma_f32_16x16x32_bf16 v[132:135], v[92:95], v[56:59], v[132:135]
    v_mfma_f32_16x16x32_bf16 v[132:135], v[96:99], v[52:55], v[132:135]
    v_mfma_f32_16x16x32_bf16 v[132:135], v[100:103], v[48:51], v[132:135]
    v_mfma_f32_16x16x32_bf16 v[128:131], v[80:83], v[64:67], v[128:131]
    v_mfma_f32_16x16x32_bf16 v[128:131], v[84:87], v[60:63], v[128:131]
    ds_write_b128 v175, v[136:139] offset:6144
    v_mfma_f32_16x16x32_bf16 v[128:131], v[88:91], v[56:59], v[128:131]
    v_mfma_f32_16x16x32_bf16 v[128:131], v[92:95], v[52:55], v[128:131]
    v_mfma_f32_16x16x32_bf16 v[128:131], v[96:99], v[48:51], v[128:131]
    v_mfma_f32_16x16x32_bf16 v[124:127], v[80:83], v[60:63], v[124:127]
    v_mfma_f32_16x16x32_bf16 v[124:127], v[84:87], v[56:59], v[124:127]
    v_mfma_f32_16x16x32_bf16 v[124:127], v[88:91], v[52:55], v[124:127]
    ds_write_b128 v175, v[132:135] offset:5120
    v_mfma_f32_16x16x32_bf16 v[124:127], v[92:95], v[48:51], v[124:127]
    v_mfma_f32_16x16x32_bf16 v[120:123], v[80:83], v[56:59], v[120:123]
    v_mfma_f32_16x16x32_bf16 v[120:123], v[84:87], v[52:55], v[120:123]
    v_mfma_f32_16x16x32_bf16 v[120:123], v[88:91], v[48:51], v[120:123]
    v_mfma_f32_16x16x32_bf16 v[116:119], v[80:83], v[52:55], v[116:119]
    ds_write_b128 v175, v[128:131] offset:4096
    v_mfma_f32_16x16x32_bf16 v[116:119], v[84:87], v[48:51], v[116:119]
    v_mfma_f32_16x16x32_bf16 v[112:115], v[80:83], v[48:51], v[112:115]
    s_nop 0
    ds_write_b128 v175, v[124:127] offset:3072
    s_nop 1
    ds_write_b128 v175, v[120:123] offset:2048
    s_nop 1
    ds_write_b128 v175, v[116:119] offset:1024
    ds_write_b128 v175, v[112:115] offset:0
    s_waitcnt lgkmcnt(0)
    s_barrier
    s_setprio 0
    s_barrier
    s_mov_b32 s58, 0x3f803f80
    s_lshr_b32 s57, s6, 2
    s_mul_i32 s14, s7, 6
    s_mul_i32 s59, s35, 3
    s_add_u32 s14, s14, s59
    s_lshl_b32 s15, s7, 1
    s_add_u32 s15, s15, s35
    s_lshl_b32 s15, s15, 11
    s_add_u32 s15, s15, 32768
    s_lshl_b32 s60, s57, 9
    s_add_u32 s60, s60, s15
    v_and_b32 v126, 15, v1
    v_lshlrev_b32 v126, 5, v126
    v_lshl_add_u32 v19, v2, 4, v126
    s_mov_b32 s61, 0x7fff0000
    s_and_b32 s56, s6, 3
    s_or_b32 s56, s56, s34
    s_cbranch_scc1 L_NOAUG
    ds_read_b64_tr_b16 v[32:33], v144 offset:0
    ds_read_b64_tr_b16 v[34:35], v144 offset:3072
    ds_read_b64_tr_b16 v[36:37], v144 offset:12288
    ds_read_b64_tr_b16 v[38:39], v144 offset:15360
    ds_read_b64_tr_b16 v[40:41], v144 offset:24576
    ds_read_b64_tr_b16 v[42:43], v144 offset:27648
    ds_read_b64_tr_b16 v[44:45], v144 offset:36864
    ds_read_b64_tr_b16 v[46:47], v144 offset:39936
    ds_read_b64_tr_b16 v[48:49], v144 offset:6144
    ds_read_b64_tr_b16 v[50:51], v144 offset:9216
    ds_read_b64_tr_b16 v[52:53], v144 offset:18432
    ds_read_b64_tr_b16 v[54:55], v144 offset:21504
    ds_read_b64_tr_b16 v[56:57], v144 offset:30720
    ds_read_b64_tr_b16 v[58:59], v144 offset:33792
    ds_read_b64_tr_b16 v[60:61], v144 offset:43008
    ds_read_b64_tr_b16 v[62:63], v144 offset:46080
    ds_read_b64_tr_b16 v[64:65], v145 offset:0
    ds_read_b64_tr_b16 v[66:67], v145 offset:3072
    ds_read_b64_tr_b16 v[68:69], v145 offset:12288
    ds_read_b64_tr_b16 v[70:71], v145 offset:15360
    ds_read_b64_tr_b16 v[72:73], v145 offset:24576
    ds_read_b64_tr_b16 v[74:75], v145 offset:27648
    ds_read_b64_tr_b16 v[76:77], v145 offset:36864
    ds_read_b64_tr_b16 v[78:79], v145 offset:39936
    ds_read_b64_tr_b16 v[80:81], v145 offset:6144
    ds_read_b64_tr_b16 v[82:83], v145 offset:9216
    ds_read_b64_tr_b16 v[84:85], v145 offset:18432
    ds_read_b64_tr_b16 v[86:87], v145 offset:21504
    ds_read_b64_tr_b16 v[88:89], v145 offset:30720
    ds_read_b64_tr_b16 v[90:91], v145 offset:33792
    ds_read_b64_tr_b16 v[92:93], v145 offset:43008
    ds_read_b64_tr_b16 v[94:95], v145 offset:46080
    ds_read_b64_tr_b16 v[96:97], v146 offset:0
    ds_read_b64_tr_b16 v[98:99], v146 offset:3072
    ds_read_b64_tr_b16 v[100:101], v146 offset:12288
    ds_read_b64_tr_b16 v[102:103], v146 offset:15360
    ds_read_b64_tr_b16 v[104:105], v146 offset:24576
    ds_read_b64_tr_b16 v[106:107], v146 offset:27648
    ds_read_b64_tr_b16 v[108:109], v146 offset:36864
    ds_read_b64_tr_b16 v[110:111], v146 offset:39936
    ds_read_b64_tr_b16 v[112:113], v146 offset:6144
    ds_read_b64_tr_b16 v[114:115], v146 offset:9216
    ds_read_b64_tr_b16 v[116:117], v146 offset:18432
    ds_read_b64_tr_b16 v[118:119], v146 offset:21504
    ds_read_b64_tr_b16 v[120:121], v146 offset:30720
    ds_read_b64_tr_b16 v[122:123], v146 offset:33792
    ds_read_b64_tr_b16 v[124:125], v146 offset:43008
    ds_read_b64_tr_b16 v[126:127], v146 offset:46080
    v_mov_b32 v20, 0
    v_mov_b32 v21, 0
    v_mov_b32 v22, 0
    v_mov_b32 v23, 0
    v_mov_b32 v24, 0
    v_mov_b32 v25, 0
    s_waitcnt lgkmcnt(15)
    v_dot2_f32_bf16 v20, v32, s58, v20
    v_dot2_f32_bf16 v21, v48, s58, v21
    v_dot2_f32_bf16 v20, v33, s58, v20
    v_dot2_f32_bf16 v21, v49, s58, v21
    v_dot2_f32_bf16 v20, v34, s58, v20
    v_dot2_f32_bf16 v21, v50, s58, v21
    v_dot2_f32_bf16 v20, v35, s58, v20
    v_dot2_f32_bf16 v21, v51, s58, v21
    v_dot2_f32_bf16 v20, v36, s58, v20
    v_dot2_f32_bf16 v21, v52, s58, v21
    v_dot2_f32_bf16 v20, v37, s58, v20
    v_dot2_f32_bf16 v21, v53, s58, v21
    v_dot2_f32_bf16 v20, v38, s58, v20
    v_dot2_f32_bf16 v21, v54, s58, v21
    v_dot2_f32_bf16 v20, v39, s58, v20
    v_dot2_f32_bf16 v21, v55, s58, v21
    v_dot2_f32_bf16 v20, v40, s58, v20
    v_dot2_f32_bf16 v21, v56, s58, v21
    v_dot2_f32_bf16 v20, v41, s58, v20
    v_dot2_f32_bf16 v21, v57, s58, v21
    v_dot2_f32_bf16 v20, v42, s58, v20
    v_dot2_f32_bf16 v21, v58, s58, v21
    v_dot2_f32_bf16 v20, v43, s58, v20
    v_dot2_f32_bf16 v21, v59, s58, v21
    v_dot2_f32_bf16 v20, v44, s58, v20
    v_dot2_f32_bf16 v21, v60, s58, v21
    v_dot2_f32_bf16 v20, v45, s58, v20
    v_dot2_f32_bf16 v21, v61, s58, v21
    v_dot2_f32_bf16 v20, v46, s58, v20
    v_dot2_f32_bf16 v21, v62, s58, v21
    v_dot2_f32_bf16 v20, v47, s58, v20
    v_dot2_f32_bf16 v21, v63, s58, v21
    s_waitcnt lgkmcnt(15)
    s_nop 0
    v_dot2_f32_bf16 v22, v64, s58, v22
    v_dot2_f32_bf16 v23, v80, s58, v23
    v_dot2_f32_bf16 v22, v65, s58, v22
    v_dot2_f32_bf16 v23, v81, s58, v23
    v_dot2_f32_bf16 v22, v66, s58, v22
    v_dot2_f32_bf16 v23, v82, s58, v23
    v_dot2_f32_bf16 v22, v67, s58, v22
    v_dot2_f32_bf16 v23, v83, s58, v23
    v_dot2_f32_bf16 v22, v68, s58, v22
    v_dot2_f32_bf16 v23, v84, s58, v23
    v_dot2_f32_bf16 v22, v69, s58, v22
    v_dot2_f32_bf16 v23, v85, s58, v23
    v_dot2_f32_bf16 v22, v70, s58, v22
    v_dot2_f32_bf16 v23, v86, s58, v23
    v_dot2_f32_bf16 v22, v71, s58, v22
    v_dot2_f32_bf16 v23, v87, s58, v23
    v_dot2_f32_bf16 v22, v72, s58, v22
    v_dot2_f32_bf16 v23, v88, s58, v23
    v_dot2_f32_bf16 v22, v73, s58, v22
    v_dot2_f32_bf16 v23, v89, s58, v23
    v_dot2_f32_bf16 v22, v74, s58, v22
    v_dot2_f32_bf16 v23, v90, s58, v23
    v_dot2_f32_bf16 v22, v75, s58, v22
    v_dot2_f32_bf16 v23, v91, s58, v23
    v_dot2_f32_bf16 v22, v76, s58, v22
    v_dot2_f32_bf16 v23, v92, s58, v23
    v_dot2_f32_bf16 v22, v77, s58, v22
    v_dot2_f32_bf16 v23, v93, s58, v23
    v_dot2_f32_bf16 v22, v78, s58, v22
    v_dot2_f32_bf16 v23, v94, s58, v23
    v_dot2_f32_bf16 v22, v79, s58, v22
    v_dot2_f32_bf16 v23, v95, s58, v23
    s_waitcnt lgkmcnt(0)
    s_nop 0
    v_dot2_f32_bf16 v24, v96, s58, v24
    v_dot2_f32_bf16 v25, v112, s58, v25
    v_dot2_f32_bf16 v24, v97, s58, v24
    v_dot2_f32_bf16 v25, v113, s58, v25
    v_dot2_f32_bf16 v24, v98, s58, v24
    v_dot2_f32_bf16 v25, v114, s58, v25
    v_dot2_f32_bf16 v24, v99, s58, v24
    v_dot2_f32_bf16 v25, v115, s58, v25
    v_dot2_f32_bf16 v24, v100, s58, v24
    v_dot2_f32_bf16 v25, v116, s58, v25
    v_dot2_f32_bf16 v24, v101, s58, v24
    v_dot2_f32_bf16 v25, v117, s58, v25
    v_dot2_f32_bf16 v24, v102, s58, v24
    v_dot2_f32_bf16 v25, v118, s58, v25
    v_dot2_f32_bf16 v24, v103, s58, v24
    v_dot2_f32_bf16 v25, v119, s58, v25
    v_dot2_f32_bf16 v24, v104, s58, v24
    v_dot2_f32_bf16 v25, v120, s58, v25
    v_dot2_f32_bf16 v24, v105, s58, v24
    v_dot2_f32_bf16 v25, v121, s58, v25
    v_dot2_f32_bf16 v24, v106, s58, v24
    v_dot2_f32_bf16 v25, v122, s58, v25
    v_dot2_f32_bf16 v24, v107, s58, v24
    v_dot2_f32_bf16 v25, v123, s58, v25
    v_dot2_f32_bf16 v24, v108, s58, v24
    v_dot2_f32_bf16 v25, v124, s58, v25
    v_dot2_f32_bf16 v24, v109, s58, v24
    v_dot2_f32_bf16 v25, v125, s58, v25
    v_dot2_f32_bf16 v24, v110, s58, v24
    v_dot2_f32_bf16 v25, v126, s58, v25
    v_dot2_f32_bf16 v24, v111, s58, v24
    v_dot2_f32_bf16 v25, v127, s58, v25
    v_permlane16_swap_b32 v20, v21
    v_permlane16_swap_b32 v22, v23
    s_nop 0
    v_permlane16_swap_b32 v24, v25
    v_add_f32 v20, v20, v21
    v_add_f32 v22, v22, v23
    v_add_f32 v24, v24, v25
    v_mov_b32 v21, v20
    v_mov_b32 v23, v22
    v_mov_b32 v25, v24
    v_permlane32_swap_b32 v20, v21
    v_permlane32_swap_b32 v22, v23
    v_permlane32_swap_b32 v24, v25
    v_add_f32 v20, v20, v21
    v_cvt_pk_bf16_f32 v21, v20, v20
    v_lshlrev_b32 v21, 16, v21
    v_sub_f32 v20, v20, v21
    v_cvt_pk_bf16_f32 v28, v21, v20
    v_add_f32_e64 v22, v22, v23
    v_cvt_pk_bf16_f32 v23, v22, v22
    v_lshlrev_b32 v23, 16, v23
    v_sub_f32 v22, v22, v23
    v_cvt_pk_bf16_f32 v29, v23, v22
    v_add_f32_e64 v24, v24, v25
    v_cvt_pk_bf16_f32 v25, v24, v24
    v_lshlrev_b32 v25, 16, v25
    v_sub_f32 v24, v24, v25
    v_cvt_pk_bf16_f32 v30, v25, v24
    buffer_store_dwordx4 v[28:31], v19, s[48:51], s60 offen sc1
    s_lshl_b32 s61, s7, 2
    s_add_u32 s61, s61, s57
    s_lshl_b32 s61, s61, 1
    s_add_u32 s61, s61, s35
    s_lshl_b32 s61, s61, 7
    s_add_u32 s61, s61, 458752
L_NOAUG:
    v_lshlrev_b32 v142, 5, v1
    v_mov_b32 v140, s30
    v_mov_b32 v141, 0
    v_add_u32 v15, 32768, v6
    s_lshl_b32 s58, s6, 11
    s_lshl_b32 s57, s34, 10
    s_add_u32 s58, s58, s57
    s_add_u32 s58, s58, 262144
    s_lshl_b32 s64, s6, 2
    s_lshl_b32 s65, s34, 1
    s_add_u32 s64, s64, s65
    s_mul_i32 s64, s64, 28
    s_lshl_b32 s65, s7, 1
    s_add_u32 s64, s64, s65
    s_add_u32 s64, s64, s35
    s_lshr_b32 s62, s64, 3
    s_lshl_b32 s62, s62, 14
    s_and_b32 s65, s64, 7
    s_lshl_b32 s65, s65, 10
    s_add_u32 s62, s62, s65
    s_add_u32 s62, s62, 5808128
    s_add_u32 s64, s64, 28
    s_lshr_b32 s63, s64, 3
    s_lshl_b32 s63, s63, 14
    s_and_b32 s65, s64, 7
    s_lshl_b32 s65, s65, 10
    s_add_u32 s63, s63, s65
    s_add_u32 s63, s63, 5808128
    s_cmp_eq_u32 s7, 15
    s_cbranch_scc1 L_STATS_G1
    s_lshl_b32 s56, s6, 2
    s_lshl_b32 s57, s34, 1
    s_add_u32 s56, s56, s57
    s_mul_i32 s56, s56, 58
    s_lshl_b32 s57, s7, 2
    s_add_u32 s56, s56, s57
    s_lshl_b32 s57, s35, 1
    s_add_u32 s56, s56, s57
    s_cmp_eq_u32 s7, 14
    s_addc_u32 s56, s56, 0
    s_lshl_b32 s56, s56, 10
    s_add_u32 s57, s56, 59392
    s_lshl_b32 s60, s6, 1
    s_add_u32 s60, s60, s34
    s_lshl_b32 s60, s60, 7
    s_add_u32 s60, s60, 196608
    s_sub_u32 s64, s56, 1024
    s_sub_u32 s65, s57, 1024
    s_cmp_eq_u32 s7, 14
    s_cselect_b32 s62, s64, s62
    s_cselect_b32 s63, s65, s63
    s_lshr_b32 s31, s3, 2
    s_lshl_b32 s20, s8, 1
    s_add_u32 s20, s20, s31
    s_mul_i32 s4, s20, 59392
    v_add_u32 v155, s4, v6
    s_lshl_b32 s20, s20, 2
    s_add_u32 s20, s20, s11
    s_mul_i32 s20, s20, 7
    s_mul_i32 s4, s11, 14336
    s_and_b32 s5, s11, 1
    s_add_u32 s5, s5, 84
    s_lshl_b32 s18, s31, 13
    s_mul_i32 s16, s11, 344064
    s_add_u32 s16, s16, s18
    s_lshl_b32 s17, s5, 14
    s_add_u32 s17, s17, s18
    s_sub_u32 s5, s5, 28
    s_lshl_b32 s5, s5, 10
    s_lshl_b32 s21, s11, 11
    s_lshl_b32 s18, s31, 10
    s_add_u32 s18, s18, s21
    v_lshl_add_u32 v14, v3, 3, v4
    v_lshlrev_b32 v14, 7, v14
    v_lshl_add_u32 v14, v2, 5, v14
    v_lshl_add_u32 v14, v5, 3, v14
    v_add_u32 v14, s21, v14
    v_lshrrev_b32 v12, 1, v4
    v_lshl_add_u32 v8, v12, 6, v14
    v_xor_b32_e64 v12, 1, v12
    v_lshl_add_u32 v10, v12, 6, v14
    v_add_u32 v11, 65536, v8
    v_add_u32 v12, 65536, v10
    v_add_u32 v14, 131072, v8
    v_add_u32 v154, 131072, v10
    s_setprio 2
    s_waitcnt vmcnt(0)
    buffer_store_dword v140, v141, s[48:51], s61 offen sc1
    s_cmp_ge_u32 s14, 86
    s_cbranch_scc1 L_IDLEW
    s_barrier
    ds_read_b64_tr_b16 v[40:41], v150 offset:0
    ds_read_b64_tr_b16 v[42:43], v150 offset:4096
    ds_read_b64_tr_b16 v[16:17], v144 offset:0
    ds_read_b64_tr_b16 v[18:19], v144 offset:3072
    ds_read_b64_tr_b16 v[44:45], v151 offset:0
    ds_read_b64_tr_b16 v[46:47], v151 offset:4096
    ds_read_b64_tr_b16 v[48:49], v152 offset:0
    ds_read_b64_tr_b16 v[50:51], v152 offset:4096
    ds_read_b64_tr_b16 v[52:53], v153 offset:0
    ds_read_b64_tr_b16 v[54:55], v153 offset:4096
    ds_read_b64_tr_b16 v[20:21], v144 offset:6144
    ds_read_b64_tr_b16 v[22:23], v144 offset:9216
    ds_read_b64_tr_b16 v[24:25], v145 offset:0
    ds_read_b64_tr_b16 v[26:27], v145 offset:3072
    ds_read_b64_tr_b16 v[28:29], v145 offset:6144
    ds_read_b64_tr_b16 v[30:31], v145 offset:9216
    ds_read_b64_tr_b16 v[32:33], v146 offset:0
    ds_read_b64_tr_b16 v[34:35], v146 offset:3072
    ds_read_b64_tr_b16 v[36:37], v146 offset:6144
    ds_read_b64_tr_b16 v[38:39], v146 offset:9216
    s_waitcnt lgkmcnt(15)
    v_mfma_f32_16x16x32_bf16 v[160:163], v[16:19], v[40:43], 0
    s_waitcnt lgkmcnt(14)
    v_mfma_f32_16x16x32_bf16 v[164:167], v[16:19], v[44:47], 0
    s_waitcnt lgkmcnt(12)
    v_mfma_f32_16x16x32_bf16 v[168:171], v[16:19], v[48:51], 0
    s_barrier
    s_waitcnt lgkmcnt(10)
    v_mfma_f32_16x16x32_bf16 v[172:175], v[16:19], v[52:55], 0
    ds_read_b64_tr_b16 v[80:81], v150 offset:8192
    s_waitcnt lgkmcnt(9)
    v_mfma_f32_16x16x32_bf16 v[176:179], v[20:23], v[40:43], 0
    ds_read_b64_tr_b16 v[82:83], v150 offset:12288
    v_mfma_f32_16x16x32_bf16 v[180:183], v[20:23], v[44:47], 0
    ds_read_b64_tr_b16 v[56:57], v144 offset:12288
    v_mfma_f32_16x16x32_bf16 v[184:187], v[20:23], v[48:51], 0
    ds_read_b64_tr_b16 v[58:59], v144 offset:15360
    v_mfma_f32_16x16x32_bf16 v[188:191], v[20:23], v[52:55], 0
    ds_read_b64_tr_b16 v[84:85], v151 offset:8192
    s_waitcnt lgkmcnt(11)
    v_mfma_f32_16x16x32_bf16 v[192:195], v[24:27], v[40:43], 0
    ds_read_b64_tr_b16 v[86:87], v151 offset:12288
    v_mfma_f32_16x16x32_bf16 v[196:199], v[24:27], v[44:47], 0
    ds_read_b64_tr_b16 v[88:89], v152 offset:8192
    v_mfma_f32_16x16x32_bf16 v[200:203], v[24:27], v[48:51], 0
    ds_read_b64_tr_b16 v[90:91], v152 offset:12288
    v_mfma_f32_16x16x32_bf16 v[204:207], v[24:27], v[52:55], 0
    ds_read_b64_tr_b16 v[92:93], v153 offset:8192
    s_waitcnt lgkmcnt(13)
    v_mfma_f32_16x16x32_bf16 v[208:211], v[28:31], v[40:43], 0
    ds_read_b64_tr_b16 v[94:95], v153 offset:12288
    v_mfma_f32_16x16x32_bf16 v[212:215], v[28:31], v[44:47], 0
    ds_read_b64_tr_b16 v[60:61], v144 offset:18432
    v_mfma_f32_16x16x32_bf16 v[216:219], v[28:31], v[48:51], 0
    ds_read_b64_tr_b16 v[62:63], v144 offset:21504
    v_mfma_f32_16x16x32_bf16 v[220:223], v[28:31], v[52:55], 0
    ds_read_b64_tr_b16 v[64:65], v145 offset:12288
    s_waitcnt lgkmcnt(15)
    v_mfma_f32_16x16x32_bf16 v[224:227], v[32:35], v[40:43], 0
    ds_read_b64_tr_b16 v[66:67], v145 offset:15360
    v_mfma_f32_16x16x32_bf16 v[228:231], v[32:35], v[44:47], 0
    ds_read_b64_tr_b16 v[68:69], v145 offset:18432
    v_mfma_f32_16x16x32_bf16 v[232:235], v[32:35], v[48:51], 0
    ds_read_b64_tr_b16 v[70:71], v145 offset:21504
    v_mfma_f32_16x16x32_bf16 v[236:239], v[32:35], v[52:55], 0
    ds_read_b64_tr_b16 v[72:73], v146 offset:12288
    s_waitcnt lgkmcnt(15)
    v_mfma_f32_16x16x32_bf16 v[240:243], v[36:39], v[40:43], 0
    ds_read_b64_tr_b16 v[74:75], v146 offset:15360
    v_mfma_f32_16x16x32_bf16 v[244:247], v[36:39], v[44:47], 0
    ds_read_b64_tr_b16 v[76:77], v146 offset:18432
    v_mfma_f32_16x16x32_bf16 v[248:251], v[36:39], v[48:51], 0
    ds_read_b64_tr_b16 v[78:79], v146 offset:21504
    v_mfma_f32_16x16x32_bf16 v[252:255], v[36:39], v[52:55], 0
    s_waitcnt lgkmcnt(15)
    v_mfma_f32_16x16x32_bf16 v[160:163], v[56:59], v[80:83], v[160:163]
    s_waitcnt lgkmcnt(14)
    v_mfma_f32_16x16x32_bf16 v[164:167], v[56:59], v[84:87], v[164:167]
    s_waitcnt lgkmcnt(12)
    v_mfma_f32_16x16x32_bf16 v[168:171], v[56:59], v[88:91], v[168:171]
    s_barrier
    s_waitcnt lgkmcnt(10)
    v_mfma_f32_16x16x32_bf16 v[172:175], v[56:59], v[92:95], v[172:175]
    ds_read_b64_tr_b16 v[40:41], v150 offset:16384
    s_waitcnt lgkmcnt(9)
    v_mfma_f32_16x16x32_bf16 v[176:179], v[60:63], v[80:83], v[176:179]
    ds_read_b64_tr_b16 v[42:43], v150 offset:20480
    v_mfma_f32_16x16x32_bf16 v[180:183], v[60:63], v[84:87], v[180:183]
    ds_read_b64_tr_b16 v[16:17], v144 offset:24576
    v_mfma_f32_16x16x32_bf16 v[184:187], v[60:63], v[88:91], v[184:187]
    ds_read_b64_tr_b16 v[18:19], v144 offset:27648
    v_mfma_f32_16x16x32_bf16 v[188:191], v[60:63], v[92:95], v[188:191]
    ds_read_b64_tr_b16 v[44:45], v151 offset:16384
    s_waitcnt lgkmcnt(11)
    v_mfma_f32_16x16x32_bf16 v[192:195], v[64:67], v[80:83], v[192:195]
    ds_read_b64_tr_b16 v[46:47], v151 offset:20480
    v_mfma_f32_16x16x32_bf16 v[196:199], v[64:67], v[84:87], v[196:199]
    ds_read_b64_tr_b16 v[48:49], v152 offset:16384
    v_mfma_f32_16x16x32_bf16 v[200:203], v[64:67], v[88:91], v[200:203]
    ds_read_b64_tr_b16 v[50:51], v152 offset:20480
    v_mfma_f32_16x16x32_bf16 v[204:207], v[64:67], v[92:95], v[204:207]
    ds_read_b64_tr_b16 v[52:53], v153 offset:16384
    s_waitcnt lgkmcnt(13)
    v_mfma_f32_16x16x32_bf16 v[208:211], v[68:71], v[80:83], v[208:211]
    ds_read_b64_tr_b16 v[54:55], v153 offset:20480
    v_mfma_f32_16x16x32_bf16 v[212:215], v[68:71], v[84:87], v[212:215]
    ds_read_b64_tr_b16 v[20:21], v144 offset:30720
    v_mfma_f32_16x16x32_bf16 v[216:219], v[68:71], v[88:91], v[216:219]
    ds_read_b64_tr_b16 v[22:23], v144 offset:33792
    v_mfma_f32_16x16x32_bf16 v[220:223], v[68:71], v[92:95], v[220:223]
    ds_read_b64_tr_b16 v[24:25], v145 offset:24576
    s_waitcnt lgkmcnt(15)
    v_mfma_f32_16x16x32_bf16 v[224:227], v[72:75], v[80:83], v[224:227]
    ds_read_b64_tr_b16 v[26:27], v145 offset:27648
    v_mfma_f32_16x16x32_bf16 v[228:231], v[72:75], v[84:87], v[228:231]
    ds_read_b64_tr_b16 v[28:29], v145 offset:30720
    v_mfma_f32_16x16x32_bf16 v[232:235], v[72:75], v[88:91], v[232:235]
    ds_read_b64_tr_b16 v[30:31], v145 offset:33792
    v_mfma_f32_16x16x32_bf16 v[236:239], v[72:75], v[92:95], v[236:239]
    ds_read_b64_tr_b16 v[32:33], v146 offset:24576
    s_waitcnt lgkmcnt(15)
    v_mfma_f32_16x16x32_bf16 v[240:243], v[76:79], v[80:83], v[240:243]
    ds_read_b64_tr_b16 v[34:35], v146 offset:27648
    v_mfma_f32_16x16x32_bf16 v[244:247], v[76:79], v[84:87], v[244:247]
    ds_read_b64_tr_b16 v[36:37], v146 offset:30720
    v_mfma_f32_16x16x32_bf16 v[248:251], v[76:79], v[88:91], v[248:251]
    ds_read_b64_tr_b16 v[38:39], v146 offset:33792
    v_mfma_f32_16x16x32_bf16 v[252:255], v[76:79], v[92:95], v[252:255]
    s_waitcnt lgkmcnt(15)
    v_mfma_f32_16x16x32_bf16 v[160:163], v[16:19], v[40:43], v[160:163]
    s_waitcnt lgkmcnt(14)
    v_mfma_f32_16x16x32_bf16 v[164:167], v[16:19], v[44:47], v[164:167]
    s_waitcnt lgkmcnt(12)
    v_mfma_f32_16x16x32_bf16 v[168:171], v[16:19], v[48:51], v[168:171]
    s_barrier
    s_waitcnt lgkmcnt(10)
    v_mfma_f32_16x16x32_bf16 v[172:175], v[16:19], v[52:55], v[172:175]
    ds_read_b64_tr_b16 v[80:81], v150 offset:24576
    s_waitcnt lgkmcnt(9)
    v_mfma_f32_16x16x32_bf16 v[176:179], v[20:23], v[40:43], v[176:179]
    ds_read_b64_tr_b16 v[82:83], v150 offset:28672
    v_mfma_f32_16x16x32_bf16 v[180:183], v[20:23], v[44:47], v[180:183]
    ds_read_b64_tr_b16 v[56:57], v144 offset:36864
    v_mfma_f32_16x16x32_bf16 v[184:187], v[20:23], v[48:51], v[184:187]
    ds_read_b64_tr_b16 v[58:59], v144 offset:39936
    v_mfma_f32_16x16x32_bf16 v[188:191], v[20:23], v[52:55], v[188:191]
    ds_read_b64_tr_b16 v[84:85], v151 offset:24576
    s_waitcnt lgkmcnt(11)
    v_mfma_f32_16x16x32_bf16 v[192:195], v[24:27], v[40:43], v[192:195]
    ds_read_b64_tr_b16 v[86:87], v151 offset:28672
    v_mfma_f32_16x16x32_bf16 v[196:199], v[24:27], v[44:47], v[196:199]
    ds_read_b64_tr_b16 v[88:89], v152 offset:24576
    v_mfma_f32_16x16x32_bf16 v[200:203], v[24:27], v[48:51], v[200:203]
    ds_read_b64_tr_b16 v[90:91], v152 offset:28672
    v_mfma_f32_16x16x32_bf16 v[204:207], v[24:27], v[52:55], v[204:207]
    ds_read_b64_tr_b16 v[92:93], v153 offset:24576
    s_waitcnt lgkmcnt(13)
    v_mfma_f32_16x16x32_bf16 v[208:211], v[28:31], v[40:43], v[208:211]
    ds_read_b64_tr_b16 v[94:95], v153 offset:28672
    v_mfma_f32_16x16x32_bf16 v[212:215], v[28:31], v[44:47], v[212:215]
    ds_read_b64_tr_b16 v[60:61], v144 offset:43008
    v_mfma_f32_16x16x32_bf16 v[216:219], v[28:31], v[48:51], v[216:219]
    ds_read_b64_tr_b16 v[62:63], v144 offset:46080
    v_mfma_f32_16x16x32_bf16 v[220:223], v[28:31], v[52:55], v[220:223]
    ds_read_b64_tr_b16 v[64:65], v145 offset:36864
    s_waitcnt lgkmcnt(15)
    v_mfma_f32_16x16x32_bf16 v[224:227], v[32:35], v[40:43], v[224:227]
    ds_read_b64_tr_b16 v[66:67], v145 offset:39936
    v_mfma_f32_16x16x32_bf16 v[228:231], v[32:35], v[44:47], v[228:231]
    ds_read_b64_tr_b16 v[68:69], v145 offset:43008
    v_mfma_f32_16x16x32_bf16 v[232:235], v[32:35], v[48:51], v[232:235]
    ds_read_b64_tr_b16 v[70:71], v145 offset:46080
    v_mfma_f32_16x16x32_bf16 v[236:239], v[32:35], v[52:55], v[236:239]
    ds_read_b64_tr_b16 v[72:73], v146 offset:36864
    s_waitcnt lgkmcnt(15)
    v_mfma_f32_16x16x32_bf16 v[240:243], v[36:39], v[40:43], v[240:243]
    ds_read_b64_tr_b16 v[74:75], v146 offset:39936
    v_mfma_f32_16x16x32_bf16 v[244:247], v[36:39], v[44:47], v[244:247]
    ds_read_b64_tr_b16 v[76:77], v146 offset:43008
    v_mfma_f32_16x16x32_bf16 v[248:251], v[36:39], v[48:51], v[248:251]
    ds_read_b64_tr_b16 v[78:79], v146 offset:46080
    v_mfma_f32_16x16x32_bf16 v[252:255], v[36:39], v[52:55], v[252:255]
    s_waitcnt lgkmcnt(15)
    v_mfma_f32_16x16x32_bf16 v[160:163], v[56:59], v[80:83], v[160:163]
    s_waitcnt lgkmcnt(14)
    v_mfma_f32_16x16x32_bf16 v[164:167], v[56:59], v[84:87], v[164:167]
    s_waitcnt lgkmcnt(12)
    v_mfma_f32_16x16x32_bf16 v[168:171], v[56:59], v[88:91], v[168:171]
    s_barrier
    s_waitcnt lgkmcnt(10)
    v_mfma_f32_16x16x32_bf16 v[172:175], v[56:59], v[92:95], v[172:175]
    ds_read_b64_tr_b16 v[40:41], v150 offset:32768
    s_waitcnt lgkmcnt(9)
    v_mfma_f32_16x16x32_bf16 v[176:179], v[60:63], v[80:83], v[176:179]
    ds_read_b64_tr_b16 v[42:43], v150 offset:36864
    v_mfma_f32_16x16x32_bf16 v[180:183], v[60:63], v[84:87], v[180:183]
    ds_read_b64_tr_b16 v[16:17], v147 offset:0
    v_mfma_f32_16x16x32_bf16 v[184:187], v[60:63], v[88:91], v[184:187]
    ds_read_b64_tr_b16 v[18:19], v147 offset:3072
    v_mfma_f32_16x16x32_bf16 v[188:191], v[60:63], v[92:95], v[188:191]
    ds_read_b64_tr_b16 v[44:45], v151 offset:32768
    s_waitcnt lgkmcnt(11)
    v_mfma_f32_16x16x32_bf16 v[192:195], v[64:67], v[80:83], v[192:195]
    ds_read_b64_tr_b16 v[46:47], v151 offset:36864
    v_mfma_f32_16x16x32_bf16 v[196:199], v[64:67], v[84:87], v[196:199]
    ds_read_b64_tr_b16 v[48:49], v152 offset:32768
    v_mfma_f32_16x16x32_bf16 v[200:203], v[64:67], v[88:91], v[200:203]
    ds_read_b64_tr_b16 v[50:51], v152 offset:36864
    v_mfma_f32_16x16x32_bf16 v[204:207], v[64:67], v[92:95], v[204:207]
    ds_read_b64_tr_b16 v[52:53], v153 offset:32768
    s_waitcnt lgkmcnt(13)
    v_mfma_f32_16x16x32_bf16 v[208:211], v[68:71], v[80:83], v[208:211]
    ds_read_b64_tr_b16 v[54:55], v153 offset:36864
    v_mfma_f32_16x16x32_bf16 v[212:215], v[68:71], v[84:87], v[212:215]
    ds_read_b64_tr_b16 v[20:21], v147 offset:6144
    v_mfma_f32_16x16x32_bf16 v[216:219], v[68:71], v[88:91], v[216:219]
    ds_read_b64_tr_b16 v[22:23], v147 offset:9216
    v_mfma_f32_16x16x32_bf16 v[220:223], v[68:71], v[92:95], v[220:223]
    ds_read_b64_tr_b16 v[24:25], v148 offset:0
    s_waitcnt lgkmcnt(15)
    v_mfma_f32_16x16x32_bf16 v[224:227], v[72:75], v[80:83], v[224:227]
    ds_read_b64_tr_b16 v[26:27], v148 offset:3072
    v_mfma_f32_16x16x32_bf16 v[228:231], v[72:75], v[84:87], v[228:231]
    ds_read_b64_tr_b16 v[28:29], v148 offset:6144
    v_mfma_f32_16x16x32_bf16 v[232:235], v[72:75], v[88:91], v[232:235]
    ds_read_b64_tr_b16 v[30:31], v148 offset:9216
    v_mfma_f32_16x16x32_bf16 v[236:239], v[72:75], v[92:95], v[236:239]
    ds_read_b64_tr_b16 v[32:33], v149 offset:0
    s_waitcnt lgkmcnt(15)
    v_mfma_f32_16x16x32_bf16 v[240:243], v[76:79], v[80:83], v[240:243]
    ds_read_b64_tr_b16 v[34:35], v149 offset:3072
    v_mfma_f32_16x16x32_bf16 v[244:247], v[76:79], v[84:87], v[244:247]
    ds_read_b64_tr_b16 v[36:37], v149 offset:6144
    v_mfma_f32_16x16x32_bf16 v[248:251], v[76:79], v[88:91], v[248:251]
    ds_read_b64_tr_b16 v[38:39], v149 offset:9216
    v_mfma_f32_16x16x32_bf16 v[252:255], v[76:79], v[92:95], v[252:255]
    s_waitcnt lgkmcnt(15)
    v_mfma_f32_16x16x32_bf16 v[160:163], v[16:19], v[40:43], v[160:163]
    s_waitcnt lgkmcnt(14)
    v_mfma_f32_16x16x32_bf16 v[164:167], v[16:19], v[44:47], v[164:167]
    s_waitcnt lgkmcnt(12)
    v_mfma_f32_16x16x32_bf16 v[168:171], v[16:19], v[48:51], v[168:171]
    s_barrier
    s_waitcnt lgkmcnt(10)
    v_mfma_f32_16x16x32_bf16 v[172:175], v[16:19], v[52:55], v[172:175]
    ds_read_b64_tr_b16 v[80:81], v150 offset:40960
    s_waitcnt lgkmcnt(9)
    v_mfma_f32_16x16x32_bf16 v[176:179], v[20:23], v[40:43], v[176:179]
    ds_read_b64_tr_b16 v[82:83], v150 offset:45056
    v_mfma_f32_16x16x32_bf16 v[180:183], v[20:23], v[44:47], v[180:183]
    ds_read_b64_tr_b16 v[56:57], v147 offset:12288
    v_mfma_f32_16x16x32_bf16 v[184:187], v[20:23], v[48:51], v[184:187]
    ds_read_b64_tr_b16 v[58:59], v147 offset:15360
    v_mfma_f32_16x16x32_bf16 v[188:191], v[20:23], v[52:55], v[188:191]
    ds_read_b64_tr_b16 v[84:85], v151 offset:40960
    s_waitcnt lgkmcnt(11)
    v_mfma_f32_16x16x32_bf16 v[192:195], v[24:27], v[40:43], v[192:195]
    ds_read_b64_tr_b16 v[86:87], v151 offset:45056
    v_mfma_f32_16x16x32_bf16 v[196:199], v[24:27], v[44:47], v[196:199]
    ds_read_b64_tr_b16 v[88:89], v152 offset:40960
    v_mfma_f32_16x16x32_bf16 v[200:203], v[24:27], v[48:51], v[200:203]
    ds_read_b64_tr_b16 v[90:91], v152 offset:45056
    v_mfma_f32_16x16x32_bf16 v[204:207], v[24:27], v[52:55], v[204:207]
    ds_read_b64_tr_b16 v[92:93], v153 offset:40960
    s_waitcnt lgkmcnt(13)
    v_mfma_f32_16x16x32_bf16 v[208:211], v[28:31], v[40:43], v[208:211]
    ds_read_b64_tr_b16 v[94:95], v153 offset:45056
    v_mfma_f32_16x16x32_bf16 v[212:215], v[28:31], v[44:47], v[212:215]
    ds_read_b64_tr_b16 v[60:61], v147 offset:18432
    v_mfma_f32_16x16x32_bf16 v[216:219], v[28:31], v[48:51], v[216:219]
    ds_read_b64_tr_b16 v[62:63], v147 offset:21504
    v_mfma_f32_16x16x32_bf16 v[220:223], v[28:31], v[52:55], v[220:223]
    ds_read_b64_tr_b16 v[64:65], v148 offset:12288
    s_waitcnt lgkmcnt(15)
    v_mfma_f32_16x16x32_bf16 v[224:227], v[32:35], v[40:43], v[224:227]
    ds_read_b64_tr_b16 v[66:67], v148 offset:15360
    v_mfma_f32_16x16x32_bf16 v[228:231], v[32:35], v[44:47], v[228:231]
    ds_read_b64_tr_b16 v[68:69], v148 offset:18432
    v_mfma_f32_16x16x32_bf16 v[232:235], v[32:35], v[48:51], v[232:235]
    ds_read_b64_tr_b16 v[70:71], v148 offset:21504
    v_mfma_f32_16x16x32_bf16 v[236:239], v[32:35], v[52:55], v[236:239]
    ds_read_b64_tr_b16 v[72:73], v149 offset:12288
    s_waitcnt lgkmcnt(15)
    v_mfma_f32_16x16x32_bf16 v[240:243], v[36:39], v[40:43], v[240:243]
    ds_read_b64_tr_b16 v[74:75], v149 offset:15360
    v_mfma_f32_16x16x32_bf16 v[244:247], v[36:39], v[44:47], v[244:247]
    ds_read_b64_tr_b16 v[76:77], v149 offset:18432
    v_mfma_f32_16x16x32_bf16 v[248:251], v[36:39], v[48:51], v[248:251]
    ds_read_b64_tr_b16 v[78:79], v149 offset:21504
    v_mfma_f32_16x16x32_bf16 v[252:255], v[36:39], v[52:55], v[252:255]
    s_waitcnt lgkmcnt(15)
    v_mfma_f32_16x16x32_bf16 v[160:163], v[56:59], v[80:83], v[160:163]
    s_waitcnt lgkmcnt(14)
    v_mfma_f32_16x16x32_bf16 v[164:167], v[56:59], v[84:87], v[164:167]
    s_waitcnt lgkmcnt(12)
    v_mfma_f32_16x16x32_bf16 v[168:171], v[56:59], v[88:91], v[168:171]
    s_barrier
    s_waitcnt lgkmcnt(10)
    v_mfma_f32_16x16x32_bf16 v[172:175], v[56:59], v[92:95], v[172:175]
    ds_read_b64_tr_b16 v[40:41], v150 offset:49152
    s_waitcnt lgkmcnt(9)
    v_mfma_f32_16x16x32_bf16 v[176:179], v[60:63], v[80:83], v[176:179]
    ds_read_b64_tr_b16 v[42:43], v150 offset:53248
    v_mfma_f32_16x16x32_bf16 v[180:183], v[60:63], v[84:87], v[180:183]
    ds_read_b64_tr_b16 v[16:17], v147 offset:24576
    v_mfma_f32_16x16x32_bf16 v[184:187], v[60:63], v[88:91], v[184:187]
    ds_read_b64_tr_b16 v[18:19], v147 offset:27648
    v_mfma_f32_16x16x32_bf16 v[188:191], v[60:63], v[92:95], v[188:191]
    ds_read_b64_tr_b16 v[44:45], v151 offset:49152
    s_waitcnt lgkmcnt(11)
    v_mfma_f32_16x16x32_bf16 v[192:195], v[64:67], v[80:83], v[192:195]
    ds_read_b64_tr_b16 v[46:47], v151 offset:53248
    v_mfma_f32_16x16x32_bf16 v[196:199], v[64:67], v[84:87], v[196:199]
    ds_read_b64_tr_b16 v[48:49], v152 offset:49152
    v_mfma_f32_16x16x32_bf16 v[200:203], v[64:67], v[88:91], v[200:203]
    ds_read_b64_tr_b16 v[50:51], v152 offset:53248
    v_mfma_f32_16x16x32_bf16 v[204:207], v[64:67], v[92:95], v[204:207]
    ds_read_b64_tr_b16 v[52:53], v153 offset:49152
    s_waitcnt lgkmcnt(13)
    v_mfma_f32_16x16x32_bf16 v[208:211], v[68:71], v[80:83], v[208:211]
    ds_read_b64_tr_b16 v[54:55], v153 offset:53248
    v_mfma_f32_16x16x32_bf16 v[212:215], v[68:71], v[84:87], v[212:215]
    ds_read_b64_tr_b16 v[20:21], v147 offset:30720
    v_mfma_f32_16x16x32_bf16 v[216:219], v[68:71], v[88:91], v[216:219]
    ds_read_b64_tr_b16 v[22:23], v147 offset:33792
    v_mfma_f32_16x16x32_bf16 v[220:223], v[68:71], v[92:95], v[220:223]
    ds_read_b64_tr_b16 v[24:25], v148 offset:24576
    s_waitcnt lgkmcnt(15)
    v_mfma_f32_16x16x32_bf16 v[224:227], v[72:75], v[80:83], v[224:227]
    ds_read_b64_tr_b16 v[26:27], v148 offset:27648
    v_mfma_f32_16x16x32_bf16 v[228:231], v[72:75], v[84:87], v[228:231]
    ds_read_b64_tr_b16 v[28:29], v148 offset:30720
    v_mfma_f32_16x16x32_bf16 v[232:235], v[72:75], v[88:91], v[232:235]
    ds_read_b64_tr_b16 v[30:31], v148 offset:33792
    v_mfma_f32_16x16x32_bf16 v[236:239], v[72:75], v[92:95], v[236:239]
    ds_read_b64_tr_b16 v[32:33], v149 offset:24576
    s_waitcnt lgkmcnt(15)
    v_mfma_f32_16x16x32_bf16 v[240:243], v[76:79], v[80:83], v[240:243]
    ds_read_b64_tr_b16 v[34:35], v149 offset:27648
    v_mfma_f32_16x16x32_bf16 v[244:247], v[76:79], v[84:87], v[244:247]
    ds_read_b64_tr_b16 v[36:37], v149 offset:30720
    v_mfma_f32_16x16x32_bf16 v[248:251], v[76:79], v[88:91], v[248:251]
    ds_read_b64_tr_b16 v[38:39], v149 offset:33792
    v_mfma_f32_16x16x32_bf16 v[252:255], v[76:79], v[92:95], v[252:255]
    s_waitcnt lgkmcnt(15)
    v_mfma_f32_16x16x32_bf16 v[160:163], v[16:19], v[40:43], v[160:163]
    s_waitcnt lgkmcnt(14)
    v_mfma_f32_16x16x32_bf16 v[164:167], v[16:19], v[44:47], v[164:167]
    s_waitcnt lgkmcnt(12)
    v_mfma_f32_16x16x32_bf16 v[168:171], v[16:19], v[48:51], v[168:171]
    s_barrier
    s_waitcnt lgkmcnt(10)
    v_mfma_f32_16x16x32_bf16 v[172:175], v[16:19], v[52:55], v[172:175]
    ds_read_b64_tr_b16 v[80:81], v150 offset:57344
    s_waitcnt lgkmcnt(9)
    v_mfma_f32_16x16x32_bf16 v[176:179], v[20:23], v[40:43], v[176:179]
    ds_read_b64_tr_b16 v[82:83], v150 offset:61440
    v_mfma_f32_16x16x32_bf16 v[180:183], v[20:23], v[44:47], v[180:183]
    ds_read_b64_tr_b16 v[56:57], v147 offset:36864
    v_mfma_f32_16x16x32_bf16 v[184:187], v[20:23], v[48:51], v[184:187]
    ds_read_b64_tr_b16 v[58:59], v147 offset:39936
    v_mfma_f32_16x16x32_bf16 v[188:191], v[20:23], v[52:55], v[188:191]
    ds_read_b64_tr_b16 v[84:85], v151 offset:57344
    s_waitcnt lgkmcnt(11)
    v_mfma_f32_16x16x32_bf16 v[192:195], v[24:27], v[40:43], v[192:195]
    ds_read_b64_tr_b16 v[86:87], v151 offset:61440
    v_mfma_f32_16x16x32_bf16 v[196:199], v[24:27], v[44:47], v[196:199]
    ds_read_b64_tr_b16 v[88:89], v152 offset:57344
    v_mfma_f32_16x16x32_bf16 v[200:203], v[24:27], v[48:51], v[200:203]
    ds_read_b64_tr_b16 v[90:91], v152 offset:61440
    v_mfma_f32_16x16x32_bf16 v[204:207], v[24:27], v[52:55], v[204:207]
    ds_read_b64_tr_b16 v[92:93], v153 offset:57344
    s_waitcnt lgkmcnt(13)
    v_mfma_f32_16x16x32_bf16 v[208:211], v[28:31], v[40:43], v[208:211]
    ds_read_b64_tr_b16 v[94:95], v153 offset:61440
    v_mfma_f32_16x16x32_bf16 v[212:215], v[28:31], v[44:47], v[212:215]
    ds_read_b64_tr_b16 v[60:61], v147 offset:43008
    v_mfma_f32_16x16x32_bf16 v[216:219], v[28:31], v[48:51], v[216:219]
    ds_read_b64_tr_b16 v[62:63], v147 offset:46080
    v_mfma_f32_16x16x32_bf16 v[220:223], v[28:31], v[52:55], v[220:223]
    ds_read_b64_tr_b16 v[64:65], v148 offset:36864
    s_waitcnt lgkmcnt(15)
    v_mfma_f32_16x16x32_bf16 v[224:227], v[32:35], v[40:43], v[224:227]
    ds_read_b64_tr_b16 v[66:67], v148 offset:39936
    v_mfma_f32_16x16x32_bf16 v[228:231], v[32:35], v[44:47], v[228:231]
    ds_read_b64_tr_b16 v[68:69], v148 offset:43008
    v_mfma_f32_16x16x32_bf16 v[232:235], v[32:35], v[48:51], v[232:235]
    ds_read_b64_tr_b16 v[70:71], v148 offset:46080
    v_mfma_f32_16x16x32_bf16 v[236:239], v[32:35], v[52:55], v[236:239]
    ds_read_b64_tr_b16 v[72:73], v149 offset:36864
    s_waitcnt lgkmcnt(15)
    v_mfma_f32_16x16x32_bf16 v[240:243], v[36:39], v[40:43], v[240:243]
    ds_read_b64_tr_b16 v[74:75], v149 offset:39936
    v_mfma_f32_16x16x32_bf16 v[244:247], v[36:39], v[44:47], v[244:247]
    ds_read_b64_tr_b16 v[76:77], v149 offset:43008
    v_mfma_f32_16x16x32_bf16 v[248:251], v[36:39], v[48:51], v[248:251]
    ds_read_b64_tr_b16 v[78:79], v149 offset:46080
    v_mfma_f32_16x16x32_bf16 v[252:255], v[36:39], v[52:55], v[252:255]
    s_waitcnt lgkmcnt(15)
    v_mfma_f32_16x16x32_bf16 v[160:163], v[56:59], v[80:83], v[160:163]
    s_waitcnt lgkmcnt(14)
    v_mfma_f32_16x16x32_bf16 v[164:167], v[56:59], v[84:87], v[164:167]
    s_waitcnt lgkmcnt(12)
    v_mfma_f32_16x16x32_bf16 v[168:171], v[56:59], v[88:91], v[168:171]
    s_barrier
    s_waitcnt lgkmcnt(10)
    v_mfma_f32_16x16x32_bf16 v[172:175], v[56:59], v[92:95], v[172:175]
    ds_read_b64_tr_b16 v[40:41], v150 offset:0
    s_waitcnt lgkmcnt(9)
    v_mfma_f32_16x16x32_bf16 v[176:179], v[60:63], v[80:83], v[176:179]
    ds_read_b64_tr_b16 v[42:43], v150 offset:4096
    v_mfma_f32_16x16x32_bf16 v[180:183], v[60:63], v[84:87], v[180:183]
    ds_read_b64_tr_b16 v[16:17], v144 offset:0
    v_mfma_f32_16x16x32_bf16 v[184:187], v[60:63], v[88:91], v[184:187]
    ds_read_b64_tr_b16 v[18:19], v144 offset:3072
    v_mfma_f32_16x16x32_bf16 v[188:191], v[60:63], v[92:95], v[188:191]
    ds_read_b64_tr_b16 v[44:45], v151 offset:0
    s_waitcnt lgkmcnt(11)
    v_mfma_f32_16x16x32_bf16 v[192:195], v[64:67], v[80:83], v[192:195]
    ds_read_b64_tr_b16 v[46:47], v151 offset:4096
    v_mfma_f32_16x16x32_bf16 v[196:199], v[64:67], v[84:87], v[196:199]
    ds_read_b64_tr_b16 v[48:49], v152 offset:0
    v_mfma_f32_16x16x32_bf16 v[200:203], v[64:67], v[88:91], v[200:203]
    ds_read_b64_tr_b16 v[50:51], v152 offset:4096
    v_mfma_f32_16x16x32_bf16 v[204:207], v[64:67], v[92:95], v[204:207]
    ds_read_b64_tr_b16 v[52:53], v153 offset:0
    s_waitcnt lgkmcnt(13)
    v_mfma_f32_16x16x32_bf16 v[208:211], v[68:71], v[80:83], v[208:211]
    ds_read_b64_tr_b16 v[54:55], v153 offset:4096
    v_mfma_f32_16x16x32_bf16 v[212:215], v[68:71], v[84:87], v[212:215]
    ds_read_b64_tr_b16 v[20:21], v144 offset:6144
    v_mfma_f32_16x16x32_bf16 v[216:219], v[68:71], v[88:91], v[216:219]
    ds_read_b64_tr_b16 v[22:23], v144 offset:9216
    v_mfma_f32_16x16x32_bf16 v[220:223], v[68:71], v[92:95], v[220:223]
    ds_read_b64_tr_b16 v[24:25], v145 offset:0
    s_waitcnt lgkmcnt(15)
    v_mfma_f32_16x16x32_bf16 v[224:227], v[72:75], v[80:83], v[224:227]
    ds_read_b64_tr_b16 v[26:27], v145 offset:3072
    v_mfma_f32_16x16x32_bf16 v[228:231], v[72:75], v[84:87], v[228:231]
    ds_read_b64_tr_b16 v[28:29], v145 offset:6144
    v_mfma_f32_16x16x32_bf16 v[232:235], v[72:75], v[88:91], v[232:235]
    ds_read_b64_tr_b16 v[30:31], v145 offset:9216
    v_mfma_f32_16x16x32_bf16 v[236:239], v[72:75], v[92:95], v[236:239]
    ds_read_b64_tr_b16 v[32:33], v146 offset:0
    s_waitcnt lgkmcnt(15)
    v_mfma_f32_16x16x32_bf16 v[240:243], v[76:79], v[80:83], v[240:243]
    ds_read_b64_tr_b16 v[34:35], v146 offset:3072
    v_mfma_f32_16x16x32_bf16 v[244:247], v[76:79], v[84:87], v[244:247]
    ds_read_b64_tr_b16 v[36:37], v146 offset:6144
    v_mfma_f32_16x16x32_bf16 v[248:251], v[76:79], v[88:91], v[248:251]
    ds_read_b64_tr_b16 v[38:39], v146 offset:9216
    v_mfma_f32_16x16x32_bf16 v[252:255], v[76:79], v[92:95], v[252:255]
    s_waitcnt lgkmcnt(15)
    v_mfma_f32_16x16x32_bf16 v[160:163], v[16:19], v[40:43], v[160:163]
    s_waitcnt lgkmcnt(14)
    v_mfma_f32_16x16x32_bf16 v[164:167], v[16:19], v[44:47], v[164:167]
    s_waitcnt lgkmcnt(12)
    v_mfma_f32_16x16x32_bf16 v[168:171], v[16:19], v[48:51], v[168:171]
    s_barrier
    s_waitcnt lgkmcnt(10)
    v_mfma_f32_16x16x32_bf16 v[172:175], v[16:19], v[52:55], v[172:175]
    ds_read_b64_tr_b16 v[80:81], v150 offset:8192
    s_waitcnt lgkmcnt(9)
    v_mfma_f32_16x16x32_bf16 v[176:179], v[20:23], v[40:43], v[176:179]
    ds_read_b64_tr_b16 v[82:83], v150 offset:12288
    v_mfma_f32_16x16x32_bf16 v[180:183], v[20:23], v[44:47], v[180:183]
    ds_read_b64_tr_b16 v[56:57], v144 offset:12288
    v_mfma_f32_16x16x32_bf16 v[184:187], v[20:23], v[48:51], v[184:187]
    ds_read_b64_tr_b16 v[58:59], v144 offset:15360
    v_mfma_f32_16x16x32_bf16 v[188:191], v[20:23], v[52:55], v[188:191]
    ds_read_b64_tr_b16 v[84:85], v151 offset:8192
    s_waitcnt lgkmcnt(11)
    v_mfma_f32_16x16x32_bf16 v[192:195], v[24:27], v[40:43], v[192:195]
    ds_read_b64_tr_b16 v[86:87], v151 offset:12288
    v_mfma_f32_16x16x32_bf16 v[196:199], v[24:27], v[44:47], v[196:199]
    ds_read_b64_tr_b16 v[88:89], v152 offset:8192
    v_mfma_f32_16x16x32_bf16 v[200:203], v[24:27], v[48:51], v[200:203]
    ds_read_b64_tr_b16 v[90:91], v152 offset:12288
    v_mfma_f32_16x16x32_bf16 v[204:207], v[24:27], v[52:55], v[204:207]
    ds_read_b64_tr_b16 v[92:93], v153 offset:8192
    s_waitcnt lgkmcnt(13)
    v_mfma_f32_16x16x32_bf16 v[208:211], v[28:31], v[40:43], v[208:211]
    ds_read_b64_tr_b16 v[94:95], v153 offset:12288
    v_mfma_f32_16x16x32_bf16 v[212:215], v[28:31], v[44:47], v[212:215]
    ds_read_b64_tr_b16 v[60:61], v144 offset:18432
    v_mfma_f32_16x16x32_bf16 v[216:219], v[28:31], v[48:51], v[216:219]
    ds_read_b64_tr_b16 v[62:63], v144 offset:21504
    v_mfma_f32_16x16x32_bf16 v[220:223], v[28:31], v[52:55], v[220:223]
    ds_read_b64_tr_b16 v[64:65], v145 offset:12288
    s_waitcnt lgkmcnt(15)
    v_mfma_f32_16x16x32_bf16 v[224:227], v[32:35], v[40:43], v[224:227]
    ds_read_b64_tr_b16 v[66:67], v145 offset:15360
    v_mfma_f32_16x16x32_bf16 v[228:231], v[32:35], v[44:47], v[228:231]
    ds_read_b64_tr_b16 v[68:69], v145 offset:18432
    v_mfma_f32_16x16x32_bf16 v[232:235], v[32:35], v[48:51], v[232:235]
    ds_read_b64_tr_b16 v[70:71], v145 offset:21504
    v_mfma_f32_16x16x32_bf16 v[236:239], v[32:35], v[52:55], v[236:239]
    ds_read_b64_tr_b16 v[72:73], v146 offset:12288
    s_waitcnt lgkmcnt(15)
    v_mfma_f32_16x16x32_bf16 v[240:243], v[36:39], v[40:43], v[240:243]
    ds_read_b64_tr_b16 v[74:75], v146 offset:15360
    v_mfma_f32_16x16x32_bf16 v[244:247], v[36:39], v[44:47], v[244:247]
    ds_read_b64_tr_b16 v[76:77], v146 offset:18432
    v_mfma_f32_16x16x32_bf16 v[248:251], v[36:39], v[48:51], v[248:251]
    ds_read_b64_tr_b16 v[78:79], v146 offset:21504
    v_mfma_f32_16x16x32_bf16 v[252:255], v[36:39], v[52:55], v[252:255]
    buffer_load_dwordx4 v[120:123], v142, s[48:51], s15 offen offset:0 sc1
    s_waitcnt lgkmcnt(15)
    v_mfma_f32_16x16x32_bf16 v[160:163], v[56:59], v[80:83], v[160:163]
    s_waitcnt lgkmcnt(14)
    v_mfma_f32_16x16x32_bf16 v[164:167], v[56:59], v[84:87], v[164:167]
    s_waitcnt lgkmcnt(12)
    v_mfma_f32_16x16x32_bf16 v[168:171], v[56:59], v[88:91], v[168:171]
    s_barrier
    s_waitcnt lgkmcnt(10)
    v_mfma_f32_16x16x32_bf16 v[172:175], v[56:59], v[92:95], v[172:175]
    ds_read_b64_tr_b16 v[40:41], v150 offset:16384
    s_waitcnt lgkmcnt(9)
    v_mfma_f32_16x16x32_bf16 v[176:179], v[60:63], v[80:83], v[176:179]
    ds_read_b64_tr_b16 v[42:43], v150 offset:20480
    v_mfma_f32_16x16x32_bf16 v[180:183], v[60:63], v[84:87], v[180:183]
    ds_read_b64_tr_b16 v[16:17], v144 offset:24576
    v_mfma_f32_16x16x32_bf16 v[184:187], v[60:63], v[88:91], v[184:187]
    ds_read_b64_tr_b16 v[18:19], v144 offset:27648
    v_mfma_f32_16x16x32_bf16 v[188:191], v[60:63], v[92:95], v[188:191]
    ds_read_b64_tr_b16 v[44:45], v151 offset:16384
    s_waitcnt lgkmcnt(11)
    v_mfma_f32_16x16x32_bf16 v[192:195], v[64:67], v[80:83], v[192:195]
    ds_read_b64_tr_b16 v[46:47], v151 offset:20480
    v_mfma_f32_16x16x32_bf16 v[196:199], v[64:67], v[84:87], v[196:199]
    ds_read_b64_tr_b16 v[48:49], v152 offset:16384
    v_mfma_f32_16x16x32_bf16 v[200:203], v[64:67], v[88:91], v[200:203]
    ds_read_b64_tr_b16 v[50:51], v152 offset:20480
    v_mfma_f32_16x16x32_bf16 v[204:207], v[64:67], v[92:95], v[204:207]
    ds_read_b64_tr_b16 v[52:53], v153 offset:16384
    s_waitcnt lgkmcnt(13)
    v_mfma_f32_16x16x32_bf16 v[208:211], v[68:71], v[80:83], v[208:211]
    ds_read_b64_tr_b16 v[54:55], v153 offset:20480
    v_mfma_f32_16x16x32_bf16 v[212:215], v[68:71], v[84:87], v[212:215]
    ds_read_b64_tr_b16 v[20:21], v144 offset:30720
    v_mfma_f32_16x16x32_bf16 v[216:219], v[68:71], v[88:91], v[216:219]
    ds_read_b64_tr_b16 v[22:23], v144 offset:33792
    v_mfma_f32_16x16x32_bf16 v[220:223], v[68:71], v[92:95], v[220:223]
    ds_read_b64_tr_b16 v[24:25], v145 offset:24576
    s_waitcnt lgkmcnt(15)
    v_mfma_f32_16x16x32_bf16 v[224:227], v[72:75], v[80:83], v[224:227]
    ds_read_b64_tr_b16 v[26:27], v145 offset:27648
    v_mfma_f32_16x16x32_bf16 v[228:231], v[72:75], v[84:87], v[228:231]
    ds_read_b64_tr_b16 v[28:29], v145 offset:30720
    v_mfma_f32_16x16x32_bf16 v[232:235], v[72:75], v[88:91], v[232:235]
    ds_read_b64_tr_b16 v[30:31], v145 offset:33792
    v_mfma_f32_16x16x32_bf16 v[236:239], v[72:75], v[92:95], v[236:239]
    ds_read_b64_tr_b16 v[32:33], v146 offset:24576
    s_waitcnt lgkmcnt(15)
    v_mfma_f32_16x16x32_bf16 v[240:243], v[76:79], v[80:83], v[240:243]
    ds_read_b64_tr_b16 v[34:35], v146 offset:27648
    v_mfma_f32_16x16x32_bf16 v[244:247], v[76:79], v[84:87], v[244:247]
    ds_read_b64_tr_b16 v[36:37], v146 offset:30720
    v_mfma_f32_16x16x32_bf16 v[248:251], v[76:79], v[88:91], v[248:251]
    ds_read_b64_tr_b16 v[38:39], v146 offset:33792
    v_mfma_f32_16x16x32_bf16 v[252:255], v[76:79], v[92:95], v[252:255]
    buffer_load_dwordx4 v[124:127], v142, s[48:51], s15 offen offset:16 sc1
    s_waitcnt lgkmcnt(15)
    v_mfma_f32_16x16x32_bf16 v[160:163], v[16:19], v[40:43], v[160:163]
    s_waitcnt lgkmcnt(14)
    v_mfma_f32_16x16x32_bf16 v[164:167], v[16:19], v[44:47], v[164:167]
    s_waitcnt lgkmcnt(12)
    v_mfma_f32_16x16x32_bf16 v[168:171], v[16:19], v[48:51], v[168:171]
    s_barrier
    s_waitcnt lgkmcnt(10)
    v_mfma_f32_16x16x32_bf16 v[172:175], v[16:19], v[52:55], v[172:175]
    ds_read_b64_tr_b16 v[80:81], v150 offset:24576
    s_waitcnt lgkmcnt(9)
    v_mfma_f32_16x16x32_bf16 v[176:179], v[20:23], v[40:43], v[176:179]
    ds_read_b64_tr_b16 v[82:83], v150 offset:28672
    v_mfma_f32_16x16x32_bf16 v[180:183], v[20:23], v[44:47], v[180:183]
    ds_read_b64_tr_b16 v[56:57], v144 offset:36864
    v_mfma_f32_16x16x32_bf16 v[184:187], v[20:23], v[48:51], v[184:187]
    ds_read_b64_tr_b16 v[58:59], v144 offset:39936
    v_mfma_f32_16x16x32_bf16 v[188:191], v[20:23], v[52:55], v[188:191]
    ds_read_b64_tr_b16 v[84:85], v151 offset:24576
    s_waitcnt lgkmcnt(11)
    v_mfma_f32_16x16x32_bf16 v[192:195], v[24:27], v[40:43], v[192:195]
    ds_read_b64_tr_b16 v[86:87], v151 offset:28672
    v_mfma_f32_16x16x32_bf16 v[196:199], v[24:27], v[44:47], v[196:199]
    ds_read_b64_tr_b16 v[88:89], v152 offset:24576
    v_mfma_f32_16x16x32_bf16 v[200:203], v[24:27], v[48:51], v[200:203]
    ds_read_b64_tr_b16 v[90:91], v152 offset:28672
    v_mfma_f32_16x16x32_bf16 v[204:207], v[24:27], v[52:55], v[204:207]
    ds_read_b64_tr_b16 v[92:93], v153 offset:24576
    s_waitcnt lgkmcnt(13)
    v_mfma_f32_16x16x32_bf16 v[208:211], v[28:31], v[40:43], v[208:211]
    ds_read_b64_tr_b16 v[94:95], v153 offset:28672
    v_mfma_f32_16x16x32_bf16 v[212:215], v[28:31], v[44:47], v[212:215]
    ds_read_b64_tr_b16 v[60:61], v144 offset:43008
    v_mfma_f32_16x16x32_bf16 v[216:219], v[28:31], v[48:51], v[216:219]
    ds_read_b64_tr_b16 v[62:63], v144 offset:46080
    v_mfma_f32_16x16x32_bf16 v[220:223], v[28:31], v[52:55], v[220:223]
    ds_read_b64_tr_b16 v[64:65], v145 offset:36864
    s_waitcnt lgkmcnt(15)
    v_mfma_f32_16x16x32_bf16 v[224:227], v[32:35], v[40:43], v[224:227]
    ds_read_b64_tr_b16 v[66:67], v145 offset:39936
    v_mfma_f32_16x16x32_bf16 v[228:231], v[32:35], v[44:47], v[228:231]
    ds_read_b64_tr_b16 v[68:69], v145 offset:43008
    v_mfma_f32_16x16x32_bf16 v[232:235], v[32:35], v[48:51], v[232:235]
    ds_read_b64_tr_b16 v[70:71], v145 offset:46080
    v_mfma_f32_16x16x32_bf16 v[236:239], v[32:35], v[52:55], v[236:239]
    ds_read_b64_tr_b16 v[72:73], v146 offset:36864
    s_waitcnt lgkmcnt(15)
    v_mfma_f32_16x16x32_bf16 v[240:243], v[36:39], v[40:43], v[240:243]
    ds_read_b64_tr_b16 v[74:75], v146 offset:39936
    v_mfma_f32_16x16x32_bf16 v[244:247], v[36:39], v[44:47], v[244:247]
    ds_read_b64_tr_b16 v[76:77], v146 offset:43008
    v_mfma_f32_16x16x32_bf16 v[248:251], v[36:39], v[48:51], v[248:251]
    ds_read_b64_tr_b16 v[78:79], v146 offset:46080
    v_mfma_f32_16x16x32_bf16 v[252:255], v[36:39], v[52:55], v[252:255]
    s_waitcnt lgkmcnt(15)
    v_mfma_f32_16x16x32_bf16 v[160:163], v[56:59], v[80:83], v[160:163]
    s_waitcnt lgkmcnt(14)
    v_mfma_f32_16x16x32_bf16 v[164:167], v[56:59], v[84:87], v[164:167]
    s_waitcnt lgkmcnt(12)
    v_mfma_f32_16x16x32_bf16 v[168:171], v[56:59], v[88:91], v[168:171]
    s_barrier
    s_waitcnt lgkmcnt(10)
    v_mfma_f32_16x16x32_bf16 v[172:175], v[56:59], v[92:95], v[172:175]
    ds_read_b64_tr_b16 v[40:41], v150 offset:32768
    s_waitcnt lgkmcnt(9)
    v_mfma_f32_16x16x32_bf16 v[176:179], v[60:63], v[80:83], v[176:179]
    ds_read_b64_tr_b16 v[42:43], v150 offset:36864
    v_mfma_f32_16x16x32_bf16 v[180:183], v[60:63], v[84:87], v[180:183]
    ds_read_b64_tr_b16 v[16:17], v147 offset:0
    v_mfma_f32_16x16x32_bf16 v[184:187], v[60:63], v[88:91], v[184:187]
    ds_read_b64_tr_b16 v[18:19], v147 offset:3072
    v_mfma_f32_16x16x32_bf16 v[188:191], v[60:63], v[92:95], v[188:191]
    ds_read_b64_tr_b16 v[44:45], v151 offset:32768
    s_waitcnt lgkmcnt(11)
    v_mfma_f32_16x16x32_bf16 v[192:195], v[64:67], v[80:83], v[192:195]
    ds_read_b64_tr_b16 v[46:47], v151 offset:36864
    v_mfma_f32_16x16x32_bf16 v[196:199], v[64:67], v[84:87], v[196:199]
    ds_read_b64_tr_b16 v[48:49], v152 offset:32768
    v_mfma_f32_16x16x32_bf16 v[200:203], v[64:67], v[88:91], v[200:203]
    ds_read_b64_tr_b16 v[50:51], v152 offset:36864
    v_mfma_f32_16x16x32_bf16 v[204:207], v[64:67], v[92:95], v[204:207]
    ds_read_b64_tr_b16 v[52:53], v153 offset:32768
    s_waitcnt lgkmcnt(13)
    v_mfma_f32_16x16x32_bf16 v[208:211], v[68:71], v[80:83], v[208:211]
    ds_read_b64_tr_b16 v[54:55], v153 offset:36864
    v_mfma_f32_16x16x32_bf16 v[212:215], v[68:71], v[84:87], v[212:215]
    ds_read_b64_tr_b16 v[20:21], v147 offset:6144
    v_mfma_f32_16x16x32_bf16 v[216:219], v[68:71], v[88:91], v[216:219]
    ds_read_b64_tr_b16 v[22:23], v147 offset:9216
    v_mfma_f32_16x16x32_bf16 v[220:223], v[68:71], v[92:95], v[220:223]
    ds_read_b64_tr_b16 v[24:25], v148 offset:0
    s_waitcnt lgkmcnt(15)
    v_mfma_f32_16x16x32_bf16 v[224:227], v[72:75], v[80:83], v[224:227]
    ds_read_b64_tr_b16 v[26:27], v148 offset:3072
    v_mfma_f32_16x16x32_bf16 v[228:231], v[72:75], v[84:87], v[228:231]
    ds_read_b64_tr_b16 v[28:29], v148 offset:6144
    v_mfma_f32_16x16x32_bf16 v[232:235], v[72:75], v[88:91], v[232:235]
    ds_read_b64_tr_b16 v[30:31], v148 offset:9216
    v_mfma_f32_16x16x32_bf16 v[236:239], v[72:75], v[92:95], v[236:239]
    ds_read_b64_tr_b16 v[32:33], v149 offset:0
    s_waitcnt lgkmcnt(15)
    v_mfma_f32_16x16x32_bf16 v[240:243], v[76:79], v[80:83], v[240:243]
    ds_read_b64_tr_b16 v[34:35], v149 offset:3072
    v_mfma_f32_16x16x32_bf16 v[244:247], v[76:79], v[84:87], v[244:247]
    ds_read_b64_tr_b16 v[36:37], v149 offset:6144
    v_mfma_f32_16x16x32_bf16 v[248:251], v[76:79], v[88:91], v[248:251]
    ds_read_b64_tr_b16 v[38:39], v149 offset:9216
    v_mfma_f32_16x16x32_bf16 v[252:255], v[76:79], v[92:95], v[252:255]
    buffer_load_dwordx4 v[96:99], v6, s[48:51], s58 offen sc1
    buffer_load_dwordx4 v[100:103], v15, s[48:51], s58 offen sc1
    s_waitcnt lgkmcnt(15)
    v_mfma_f32_16x16x32_bf16 v[160:163], v[16:19], v[40:43], v[160:163]
    s_waitcnt lgkmcnt(14)
    v_mfma_f32_16x16x32_bf16 v[164:167], v[16:19], v[44:47], v[164:167]
    s_waitcnt lgkmcnt(12)
    v_mfma_f32_16x16x32_bf16 v[168:171], v[16:19], v[48:51], v[168:171]
    s_barrier
    s_waitcnt lgkmcnt(10)
    v_mfma_f32_16x16x32_bf16 v[172:175], v[16:19], v[52:55], v[172:175]
    ds_read_b64_tr_b16 v[80:81], v150 offset:40960
    s_waitcnt lgkmcnt(9)
    v_mfma_f32_16x16x32_bf16 v[176:179], v[20:23], v[40:43], v[176:179]
    ds_read_b64_tr_b16 v[82:83], v150 offset:45056
    v_mfma_f32_16x16x32_bf16 v[180:183], v[20:23], v[44:47], v[180:183]
    ds_read_b64_tr_b16 v[56:57], v147 offset:12288
    v_mfma_f32_16x16x32_bf16 v[184:187], v[20:23], v[48:51], v[184:187]
    ds_read_b64_tr_b16 v[58:59], v147 offset:15360
    v_mfma_f32_16x16x32_bf16 v[188:191], v[20:23], v[52:55], v[188:191]
    ds_read_b64_tr_b16 v[84:85], v151 offset:40960
    s_waitcnt lgkmcnt(11)
    v_mfma_f32_16x16x32_bf16 v[192:195], v[24:27], v[40:43], v[192:195]
    ds_read_b64_tr_b16 v[86:87], v151 offset:45056
    v_mfma_f32_16x16x32_bf16 v[196:199], v[24:27], v[44:47], v[196:199]
    ds_read_b64_tr_b16 v[88:89], v152 offset:40960
    v_mfma_f32_16x16x32_bf16 v[200:203], v[24:27], v[48:51], v[200:203]
    ds_read_b64_tr_b16 v[90:91], v152 offset:45056
    v_mfma_f32_16x16x32_bf16 v[204:207], v[24:27], v[52:55], v[204:207]
    ds_read_b64_tr_b16 v[92:93], v153 offset:40960
    s_waitcnt lgkmcnt(13)
    v_mfma_f32_16x16x32_bf16 v[208:211], v[28:31], v[40:43], v[208:211]
    ds_read_b64_tr_b16 v[94:95], v153 offset:45056
    v_mfma_f32_16x16x32_bf16 v[212:215], v[28:31], v[44:47], v[212:215]
    ds_read_b64_tr_b16 v[60:61], v147 offset:18432
    v_mfma_f32_16x16x32_bf16 v[216:219], v[28:31], v[48:51], v[216:219]
    ds_read_b64_tr_b16 v[62:63], v147 offset:21504
    v_mfma_f32_16x16x32_bf16 v[220:223], v[28:31], v[52:55], v[220:223]
    ds_read_b64_tr_b16 v[64:65], v148 offset:12288
    s_waitcnt lgkmcnt(15)
    v_mfma_f32_16x16x32_bf16 v[224:227], v[32:35], v[40:43], v[224:227]
    ds_read_b64_tr_b16 v[66:67], v148 offset:15360
    v_mfma_f32_16x16x32_bf16 v[228:231], v[32:35], v[44:47], v[228:231]
    ds_read_b64_tr_b16 v[68:69], v148 offset:18432
    v_mfma_f32_16x16x32_bf16 v[232:235], v[32:35], v[48:51], v[232:235]
    ds_read_b64_tr_b16 v[70:71], v148 offset:21504
    v_mfma_f32_16x16x32_bf16 v[236:239], v[32:35], v[52:55], v[236:239]
    ds_read_b64_tr_b16 v[72:73], v149 offset:12288
    s_waitcnt lgkmcnt(15)
    v_mfma_f32_16x16x32_bf16 v[240:243], v[36:39], v[40:43], v[240:243]
    ds_read_b64_tr_b16 v[74:75], v149 offset:15360
    v_mfma_f32_16x16x32_bf16 v[244:247], v[36:39], v[44:47], v[244:247]
    ds_read_b64_tr_b16 v[76:77], v149 offset:18432
    v_mfma_f32_16x16x32_bf16 v[248:251], v[36:39], v[48:51], v[248:251]
    ds_read_b64_tr_b16 v[78:79], v149 offset:21504
    v_mfma_f32_16x16x32_bf16 v[252:255], v[36:39], v[52:55], v[252:255]
    s_waitcnt lgkmcnt(15)
    v_mfma_f32_16x16x32_bf16 v[160:163], v[56:59], v[80:83], v[160:163]
    s_waitcnt lgkmcnt(14)
    v_mfma_f32_16x16x32_bf16 v[164:167], v[56:59], v[84:87], v[164:167]
    s_waitcnt lgkmcnt(12)
    v_mfma_f32_16x16x32_bf16 v[168:171], v[56:59], v[88:91], v[168:171]
    s_barrier
    s_waitcnt lgkmcnt(10)
    v_mfma_f32_16x16x32_bf16 v[172:175], v[56:59], v[92:95], v[172:175]
    ds_read_b64_tr_b16 v[40:41], v150 offset:49152
    s_waitcnt lgkmcnt(9)
    v_mfma_f32_16x16x32_bf16 v[176:179], v[60:63], v[80:83], v[176:179]
    ds_read_b64_tr_b16 v[42:43], v150 offset:53248
    v_mfma_f32_16x16x32_bf16 v[180:183], v[60:63], v[84:87], v[180:183]
    ds_read_b64_tr_b16 v[16:17], v147 offset:24576
    v_mfma_f32_16x16x32_bf16 v[184:187], v[60:63], v[88:91], v[184:187]
    ds_read_b64_tr_b16 v[18:19], v147 offset:27648
    v_mfma_f32_16x16x32_bf16 v[188:191], v[60:63], v[92:95], v[188:191]
    ds_read_b64_tr_b16 v[44:45], v151 offset:49152
    s_waitcnt lgkmcnt(11)
    v_mfma_f32_16x16x32_bf16 v[192:195], v[64:67], v[80:83], v[192:195]
    ds_read_b64_tr_b16 v[46:47], v151 offset:53248
    v_mfma_f32_16x16x32_bf16 v[196:199], v[64:67], v[84:87], v[196:199]
    ds_read_b64_tr_b16 v[48:49], v152 offset:49152
    v_mfma_f32_16x16x32_bf16 v[200:203], v[64:67], v[88:91], v[200:203]
    ds_read_b64_tr_b16 v[50:51], v152 offset:53248
    v_mfma_f32_16x16x32_bf16 v[204:207], v[64:67], v[92:95], v[204:207]
    ds_read_b64_tr_b16 v[52:53], v153 offset:49152
    s_waitcnt lgkmcnt(13)
    v_mfma_f32_16x16x32_bf16 v[208:211], v[68:71], v[80:83], v[208:211]
    ds_read_b64_tr_b16 v[54:55], v153 offset:53248
    v_mfma_f32_16x16x32_bf16 v[212:215], v[68:71], v[84:87], v[212:215]
    ds_read_b64_tr_b16 v[20:21], v147 offset:30720
    v_mfma_f32_16x16x32_bf16 v[216:219], v[68:71], v[88:91], v[216:219]
    ds_read_b64_tr_b16 v[22:23], v147 offset:33792
    v_mfma_f32_16x16x32_bf16 v[220:223], v[68:71], v[92:95], v[220:223]
    ds_read_b64_tr_b16 v[24:25], v148 offset:24576
    s_waitcnt lgkmcnt(15)
    v_mfma_f32_16x16x32_bf16 v[224:227], v[72:75], v[80:83], v[224:227]
    ds_read_b64_tr_b16 v[26:27], v148 offset:27648
    v_mfma_f32_16x16x32_bf16 v[228:231], v[72:75], v[84:87], v[228:231]
    ds_read_b64_tr_b16 v[28:29], v148 offset:30720
    v_mfma_f32_16x16x32_bf16 v[232:235], v[72:75], v[88:91], v[232:235]
    ds_read_b64_tr_b16 v[30:31], v148 offset:33792
    v_mfma_f32_16x16x32_bf16 v[236:239], v[72:75], v[92:95], v[236:239]
    ds_read_b64_tr_b16 v[32:33], v149 offset:24576
    s_waitcnt lgkmcnt(15)
    v_mfma_f32_16x16x32_bf16 v[240:243], v[76:79], v[80:83], v[240:243]
    ds_read_b64_tr_b16 v[34:35], v149 offset:27648
    v_mfma_f32_16x16x32_bf16 v[244:247], v[76:79], v[84:87], v[244:247]
    ds_read_b64_tr_b16 v[36:37], v149 offset:30720
    v_mfma_f32_16x16x32_bf16 v[248:251], v[76:79], v[88:91], v[248:251]
    ds_read_b64_tr_b16 v[38:39], v149 offset:33792
    v_mfma_f32_16x16x32_bf16 v[252:255], v[76:79], v[92:95], v[252:255]
    s_waitcnt vmcnt(0)
L_STATCHK:
    v_min3_u32 v128, v97, v99, v101
    v_max3_u32 v129, v97, v99, v101
    v_min3_u32 v128, v128, v103, s30
    v_max3_u32 v129, v129, v103, s30
    v_cmp_ne_u32 vcc, v128, v129
    s_cbranch_vccnz L_STATRETRY
L_STATOK:
    s_waitcnt lgkmcnt(15)
    v_mfma_f32_16x16x32_bf16 v[160:163], v[16:19], v[40:43], v[160:163]
    v_add_f32 v96, v96, v100
    s_waitcnt lgkmcnt(14)
    v_mfma_f32_16x16x32_bf16 v[164:167], v[16:19], v[44:47], v[164:167]
    v_add_f32 v98, v98, v102
    s_waitcnt lgkmcnt(12)
    v_mfma_f32_16x16x32_bf16 v[168:171], v[16:19], v[48:51], v[168:171]
    s_barrier
    v_mul_f32 v96, 0x3b000000, v96
    s_waitcnt lgkmcnt(10)
    v_mfma_f32_16x16x32_bf16 v[172:175], v[16:19], v[52:55], v[172:175]
    ds_read_b64_tr_b16 v[80:81], v150 offset:57344
    v_mul_f32 v98, 0x3b000000, v98
    s_waitcnt lgkmcnt(9)
    v_mfma_f32_16x16x32_bf16 v[176:179], v[20:23], v[40:43], v[176:179]
    ds_read_b64_tr_b16 v[82:83], v150 offset:61440
    v_fma_f32 v98, -v96, v96, v98
    v_mfma_f32_16x16x32_bf16 v[180:183], v[20:23], v[44:47], v[180:183]
    ds_read_b64_tr_b16 v[56:57], v147 offset:36864
    v_max_f32 v98, 0, v98
    v_mfma_f32_16x16x32_bf16 v[184:187], v[20:23], v[48:51], v[184:187]
    ds_read_b64_tr_b16 v[58:59], v147 offset:39936
    v_cvt_pk_bf16_f32 v97, v96, v98
    v_mfma_f32_16x16x32_bf16 v[188:191], v[20:23], v[52:55], v[188:191]
    ds_read_b64_tr_b16 v[84:85], v151 offset:57344
    v_lshlrev_b32 v96, 16, v97
    s_waitcnt lgkmcnt(11)
    v_mfma_f32_16x16x32_bf16 v[192:195], v[24:27], v[40:43], v[192:195]
    ds_read_b64_tr_b16 v[86:87], v151 offset:61440
    v_and_b32 v99, 0xffff0000, v97
    v_mfma_f32_16x16x32_bf16 v[196:199], v[24:27], v[44:47], v[196:199]
    ds_read_b64_tr_b16 v[88:89], v152 offset:57344
    v_add_f32 v99, 0x3727c5ac, v99
    v_mfma_f32_16x16x32_bf16 v[200:203], v[24:27], v[48:51], v[200:203]
    ds_read_b64_tr_b16 v[90:91], v152 offset:61440
    v_cvt_pk_bf16_f32 v99, v99, v99
    v_mfma_f32_16x16x32_bf16 v[204:207], v[24:27], v[52:55], v[204:207]
    ds_read_b64_tr_b16 v[92:93], v153 offset:57344
    v_lshlrev_b32 v99, 16, v99
    s_waitcnt lgkmcnt(13)
    v_mfma_f32_16x16x32_bf16 v[208:211], v[28:31], v[40:43], v[208:211]
    ds_read_b64_tr_b16 v[94:95], v153 offset:61440
    v_sqrt_f32_e64 v99, v99
    v_mfma_f32_16x16x32_bf16 v[212:215], v[28:31], v[44:47], v[212:215]
    ds_read_b64_tr_b16 v[60:61], v147 offset:43008
    v_cvt_pk_bf16_f32 v99, v99, v99
    v_mfma_f32_16x16x32_bf16 v[216:219], v[28:31], v[48:51], v[216:219]
    ds_read_b64_tr_b16 v[62:63], v147 offset:46080
    v_lshlrev_b32 v99, 16, v99
    v_mfma_f32_16x16x32_bf16 v[220:223], v[28:31], v[52:55], v[220:223]
    ds_read_b64_tr_b16 v[64:65], v148 offset:36864
    v_rcp_f32 v100, v99
    s_waitcnt lgkmcnt(15)
    v_mfma_f32_16x16x32_bf16 v[224:227], v[32:35], v[40:43], v[224:227]
    ds_read_b64_tr_b16 v[66:67], v148 offset:39936
    v_cvt_pk_bf16_f32 v107, -v96, -v96
    v_mfma_f32_16x16x32_bf16 v[228:231], v[32:35], v[44:47], v[228:231]
    ds_read_b64_tr_b16 v[68:69], v148 offset:43008
    v_mul_f32 v106, v99, v99
    v_mfma_f32_16x16x32_bf16 v[232:235], v[32:35], v[48:51], v[232:235]
    ds_read_b64_tr_b16 v[70:71], v148 offset:46080
    v_mul_f32 v105, 0xc0135761, v100
    v_mfma_f32_16x16x32_bf16 v[236:239], v[32:35], v[52:55], v[236:239]
    ds_read_b64_tr_b16 v[72:73], v149 offset:36864
    v_mul_f32 v104, v100, v100
    s_waitcnt lgkmcnt(15)
    v_mfma_f32_16x16x32_bf16 v[240:243], v[36:39], v[40:43], v[240:243]
    ds_read_b64_tr_b16 v[74:75], v149 offset:39936
    v_mul_f32_e64 v104, v104, v100
    v_mfma_f32_16x16x32_bf16 v[244:247], v[36:39], v[44:47], v[244:247]
    ds_read_b64_tr_b16 v[76:77], v149 offset:43008
    v_mul_f32 v104, 0xbdd2d3e8, v104
    v_mfma_f32_16x16x32_bf16 v[248:251], v[36:39], v[48:51], v[248:251]
    ds_read_b64_tr_b16 v[78:79], v149 offset:46080
    v_mov_b32 v111, v107
    v_mfma_f32_16x16x32_bf16 v[252:255], v[36:39], v[52:55], v[252:255]
    v_mov_b32 v110, v106
    s_waitcnt lgkmcnt(15)
    v_mfma_f32_16x16x32_bf16 v[160:163], v[56:59], v[80:83], v[160:163]
    v_mov_b32 v109, v105
    v_mov_b32 v41, 0
    s_waitcnt lgkmcnt(14)
    v_mfma_f32_16x16x32_bf16 v[164:167], v[56:59], v[84:87], v[164:167]
    v_mov_b32 v108, v104
    v_mov_b32 v42, 0
    s_waitcnt lgkmcnt(12)
    v_mfma_f32_16x16x32_bf16 v[168:171], v[56:59], v[88:91], v[168:171]
    v_permlane16_swap_b32 v107, v111
    v_mov_b32 v43, 0
    s_waitcnt lgkmcnt(10)
    v_mfma_f32_16x16x32_bf16 v[172:175], v[56:59], v[92:95], v[172:175]
    v_permlane16_swap_b32 v106, v110
    v_mov_b32 v45, 0
    s_waitcnt lgkmcnt(8)
    v_mfma_f32_16x16x32_bf16 v[176:179], v[60:63], v[80:83], v[176:179]
    v_permlane16_swap_b32 v105, v109
    v_mov_b32 v46, 0
    v_mfma_f32_16x16x32_bf16 v[180:183], v[60:63], v[84:87], v[180:183]
    v_permlane16_swap_b32 v104, v108
    v_mov_b32 v47, 0
    v_mfma_f32_16x16x32_bf16 v[184:187], v[60:63], v[88:91], v[184:187]
    v_mov_b32 v112, v104
    v_mov_b32 v49, 0
    v_mfma_f32_16x16x32_bf16 v[188:191], v[60:63], v[92:95], v[188:191]
    v_mov_b32 v113, v105
    v_mov_b32 v50, 0
    s_waitcnt lgkmcnt(6)
    v_mfma_f32_16x16x32_bf16 v[192:195], v[64:67], v[80:83], v[192:195]
    v_mov_b32 v114, v106
    v_mov_b32 v51, 0
    v_mfma_f32_16x16x32_bf16 v[196:199], v[64:67], v[84:87], v[196:199]
    v_mov_b32 v115, v107
    v_mov_b32 v53, 0
    v_mfma_f32_16x16x32_bf16 v[200:203], v[64:67], v[88:91], v[200:203]
    v_mov_b32 v116, v108
    v_mov_b32 v54, 0
    v_mfma_f32_16x16x32_bf16 v[204:207], v[64:67], v[92:95], v[204:207]
    v_mov_b32 v117, v109
    v_mov_b32 v55, 0
    s_waitcnt lgkmcnt(4)
    v_mfma_f32_16x16x32_bf16 v[208:211], v[68:71], v[80:83], v[208:211]
    v_mov_b32 v118, v110
    v_mov_b32 v16, v120
    v_mfma_f32_16x16x32_bf16 v[212:215], v[68:71], v[84:87], v[212:215]
    v_mov_b32 v119, v111
    v_mov_b32 v20, v124
    v_mfma_f32_16x16x32_bf16 v[216:219], v[68:71], v[88:91], v[216:219]
    v_permlane32_swap_b32 v104, v112
    v_mov_b32 v24, v121
    v_mfma_f32_16x16x32_bf16 v[220:223], v[68:71], v[92:95], v[220:223]
    v_permlane32_swap_b32 v105, v113
    v_mov_b32 v28, v125
    s_waitcnt lgkmcnt(2)
    v_mfma_f32_16x16x32_bf16 v[224:227], v[72:75], v[80:83], v[224:227]
    v_permlane32_swap_b32 v106, v114
    v_mov_b32 v32, v122
    v_mfma_f32_16x16x32_bf16 v[228:231], v[72:75], v[84:87], v[228:231]
    v_permlane32_swap_b32 v107, v115
    v_mov_b32 v36, v126
    v_mfma_f32_16x16x32_bf16 v[232:235], v[72:75], v[88:91], v[232:235]
    v_permlane32_swap_b32 v108, v116
    v_mfma_f32_16x16x32_bf16 v[236:239], v[72:75], v[92:95], v[236:239]
    v_permlane32_swap_b32 v109, v117
    s_waitcnt lgkmcnt(0)
    v_mfma_f32_16x16x32_bf16 v[240:243], v[76:79], v[80:83], v[240:243]
    v_permlane32_swap_b32 v110, v118
    v_mfma_f32_16x16x32_bf16 v[244:247], v[76:79], v[84:87], v[244:247]
    v_permlane32_swap_b32 v111, v119
    v_mov_b32 v40, v107
    v_mov_b32 v44, v111
    v_mfma_f32_16x16x32_bf16 v[248:251], v[76:79], v[88:91], v[248:251]
    v_mov_b32 v48, v115
    v_mov_b32 v52, v119
    v_mfma_f32_16x16x32_bf16 v[252:255], v[76:79], v[92:95], v[252:255]
    s_barrier
    v_mfma_f32_16x16x32_bf16 v[160:163], v[16:19], v[40:43], v[160:163]
    v_mfma_f32_16x16x32_bf16 v[164:167], v[16:19], v[44:47], v[164:167]
    v_mfma_f32_16x16x32_bf16 v[168:171], v[16:19], v[48:51], v[168:171]
    v_mfma_f32_16x16x32_bf16 v[172:175], v[16:19], v[52:55], v[172:175]
    v_mfma_f32_16x16x32_bf16 v[176:179], v[20:23], v[40:43], v[176:179]
    v_mfma_f32_16x16x32_bf16 v[180:183], v[20:23], v[44:47], v[180:183]
    v_mfma_f32_16x16x32_bf16 v[184:187], v[20:23], v[48:51], v[184:187]
    v_mfma_f32_16x16x32_bf16 v[188:191], v[20:23], v[52:55], v[188:191]
    v_mfma_f32_16x16x32_bf16 v[192:195], v[24:27], v[40:43], v[192:195]
    v_mfma_f32_16x16x32_bf16 v[196:199], v[24:27], v[44:47], v[196:199]
    v_mfma_f32_16x16x32_bf16 v[200:203], v[24:27], v[48:51], v[200:203]
    v_mfma_f32_16x16x32_bf16 v[204:207], v[24:27], v[52:55], v[204:207]
    v_mfma_f32_16x16x32_bf16 v[208:211], v[28:31], v[40:43], v[208:211]
    v_mfma_f32_16x16x32_bf16 v[212:215], v[28:31], v[44:47], v[212:215]
    v_mfma_f32_16x16x32_bf16 v[216:219], v[28:31], v[48:51], v[216:219]
    v_mfma_f32_16x16x32_bf16 v[220:223], v[28:31], v[52:55], v[220:223]
    v_mfma_f32_16x16x32_bf16 v[224:227], v[32:35], v[40:43], v[224:227]
    v_mfma_f32_16x16x32_bf16 v[228:231], v[32:35], v[44:47], v[228:231]
    v_mfma_f32_16x16x32_bf16 v[232:235], v[32:35], v[48:51], v[232:235]
    v_mfma_f32_16x16x32_bf16 v[236:239], v[32:35], v[52:55], v[236:239]
    v_mfma_f32_16x16x32_bf16 v[240:243], v[36:39], v[40:43], v[240:243]
    v_mfma_f32_16x16x32_bf16 v[244:247], v[36:39], v[44:47], v[244:247]
    v_mfma_f32_16x16x32_bf16 v[248:251], v[36:39], v[48:51], v[248:251]
    v_mfma_f32_16x16x32_bf16 v[252:255], v[36:39], v[52:55], v[252:255]
    s_cmp_ge_u32 s14, 86
    s_cbranch_scc1 L_EPI_SHORT
    s_nop 0
    v_pk_mul_f32 v[56:57], v[160:161], v[160:161]
    v_pk_mul_f32 v[58:59], v[162:163], v[162:163]
    v_pk_mul_f32 v[60:61], v[164:165], v[164:165]
    v_pk_mul_f32 v[62:63], v[166:167], v[166:167]
    v_pk_fma_f32 v[56:57], v[56:57], v[104:105], v[104:105] op_sel:[0,0,1] op_sel_hi:[1,0,1]
    v_pk_fma_f32 v[58:59], v[58:59], v[104:105], v[104:105] op_sel:[0,0,1] op_sel_hi:[1,0,1]
    v_pk_fma_f32 v[60:61], v[60:61], v[108:109], v[108:109] op_sel:[0,0,1] op_sel_hi:[1,0,1]
    v_pk_fma_f32 v[62:63], v[62:63], v[108:109], v[108:109] op_sel:[0,0,1] op_sel_hi:[1,0,1]
    v_pk_mul_f32 v[56:57], v[56:57], v[160:161]
    v_pk_mul_f32 v[58:59], v[58:59], v[162:163]
    v_pk_mul_f32 v[60:61], v[60:61], v[164:165]
    v_pk_mul_f32 v[62:63], v[62:63], v[166:167]
    v_exp_f32 v56, v56
    v_exp_f32 v57, v57
    v_exp_f32 v58, v58
    v_exp_f32 v59, v59
    v_exp_f32 v60, v60
    v_exp_f32 v61, v61
    v_exp_f32 v62, v62
    v_exp_f32 v63, v63
    v_pk_mul_f32 v[176:177], v[176:177], v[160:161]
    v_pk_mul_f32 v[178:179], v[178:179], v[162:163]
    v_pk_mul_f32 v[180:181], v[180:181], v[164:165]
    v_pk_mul_f32 v[182:183], v[182:183], v[166:167]
    v_pk_fma_f32 v[56:57], v[56:57], v[106:107], v[106:107] op_sel:[0,0,0] op_sel_hi:[1,0,0]
    v_pk_fma_f32 v[58:59], v[58:59], v[106:107], v[106:107] op_sel:[0,0,0] op_sel_hi:[1,0,0]
    v_pk_fma_f32 v[60:61], v[60:61], v[110:111], v[110:111] op_sel:[0,0,0] op_sel_hi:[1,0,0]
    v_pk_fma_f32 v[62:63], v[62:63], v[110:111], v[110:111] op_sel:[0,0,0] op_sel_hi:[1,0,0]
    v_rcp_f32 v56, v56
    v_rcp_f32 v57, v57
    v_rcp_f32 v58, v58
    v_rcp_f32 v59, v59
    v_rcp_f32 v60, v60
    v_rcp_f32 v61, v61
    v_rcp_f32 v62, v62
    v_rcp_f32 v63, v63
    v_pk_mul_f32 v[176:177], v[176:177], v[56:57]
    v_pk_mul_f32 v[178:179], v[178:179], v[58:59]
    v_pk_mul_f32 v[180:181], v[180:181], v[60:61]
    v_pk_mul_f32 v[182:183], v[182:183], v[62:63]
    v_cvt_pk_bf16_f32 v128, v176, v177
    v_cvt_pk_bf16_f32 v130, v180, v181
    v_cvt_pk_bf16_f32 v129, v178, v179
    v_cvt_pk_bf16_f32 v131, v182, v183
    v_permlane16_swap_b32 v128, v130
    s_nop 0
    v_permlane16_swap_b32 v129, v131
    s_nop 0
    buffer_store_dwordx4 v[128:131], v6, s[44:47], s62 offen offset:0 sc1
    v_pk_mul_f32 v[56:57], v[168:169], v[168:169]
    v_pk_mul_f32 v[58:59], v[170:171], v[170:171]
    v_pk_mul_f32 v[60:61], v[172:173], v[172:173]
    v_pk_mul_f32 v[62:63], v[174:175], v[174:175]
    v_pk_fma_f32 v[56:57], v[56:57], v[112:113], v[112:113] op_sel:[0,0,1] op_sel_hi:[1,0,1]
    v_pk_fma_f32 v[58:59], v[58:59], v[112:113], v[112:113] op_sel:[0,0,1] op_sel_hi:[1,0,1]
    v_pk_fma_f32 v[60:61], v[60:61], v[116:117], v[116:117] op_sel:[0,0,1] op_sel_hi:[1,0,1]
    v_pk_fma_f32 v[62:63], v[62:63], v[116:117], v[116:117] op_sel:[0,0,1] op_sel_hi:[1,0,1]
    v_pk_mul_f32 v[56:57], v[56:57], v[168:169]
    v_pk_mul_f32 v[58:59], v[58:59], v[170:171]
    v_pk_mul_f32 v[60:61], v[60:61], v[172:173]
    v_pk_mul_f32 v[62:63], v[62:63], v[174:175]
    v_exp_f32 v56, v56
    v_exp_f32 v57, v57
    v_exp_f32 v58, v58
    v_exp_f32 v59, v59
    v_exp_f32 v60, v60
    v_exp_f32 v61, v61
    v_exp_f32 v62, v62
    v_exp_f32 v63, v63
    v_pk_mul_f32 v[184:185], v[184:185], v[168:169]
    v_pk_mul_f32 v[186:187], v[186:187], v[170:171]
    v_pk_mul_f32 v[188:189], v[188:189], v[172:173]
    v_pk_mul_f32 v[190:191], v[190:191], v[174:175]
    v_pk_fma_f32 v[56:57], v[56:57], v[114:115], v[114:115] op_sel:[0,0,0] op_sel_hi:[1,0,0]
    v_pk_fma_f32 v[58:59], v[58:59], v[114:115], v[114:115] op_sel:[0,0,0] op_sel_hi:[1,0,0]
    v_pk_fma_f32 v[60:61], v[60:61], v[118:119], v[118:119] op_sel:[0,0,0] op_sel_hi:[1,0,0]
    v_pk_fma_f32 v[62:63], v[62:63], v[118:119], v[118:119] op_sel:[0,0,0] op_sel_hi:[1,0,0]
    v_rcp_f32 v56, v56
    v_rcp_f32 v57, v57
    v_rcp_f32 v58, v58
    v_rcp_f32 v59, v59
    v_rcp_f32 v60, v60
    v_rcp_f32 v61, v61
    v_rcp_f32 v62, v62
    v_rcp_f32 v63, v63
    v_pk_mul_f32 v[184:185], v[184:185], v[56:57]
    v_pk_mul_f32 v[186:187], v[186:187], v[58:59]
    v_pk_mul_f32 v[188:189], v[188:189], v[60:61]
    v_pk_mul_f32 v[190:191], v[190:191], v[62:63]
    v_cvt_pk_bf16_f32 v132, v184, v185
    v_cvt_pk_bf16_f32 v134, v188, v189
    v_cvt_pk_bf16_f32 v133, v186, v187
    v_cvt_pk_bf16_f32 v135, v190, v191
    v_permlane16_swap_b32 v132, v134
    s_nop 0
    v_permlane16_swap_b32 v133, v135
    buffer_store_dwordx4 v[132:135], v6, s[44:47], s63 offen offset:0 sc1
    s_cmp_ge_u32 s14, 85
    s_cbranch_scc1 L_EPI_SHORT
    s_cmp_lg_u32 s14, 0
    s_cbranch_scc1 L_NOHINT
    buffer_store_dword v140, v141, s[48:51], s60 offen offset:0 sc1
L_NOHINT:
    v_pk_mul_f32 v[56:57], v[192:193], v[192:193]
    v_pk_mul_f32 v[58:59], v[194:195], v[194:195]
    v_pk_mul_f32 v[60:61], v[196:197], v[196:197]
    v_pk_mul_f32 v[62:63], v[198:199], v[198:199]
    v_pk_fma_f32 v[56:57], v[56:57], v[104:105], v[104:105] op_sel:[0,0,1] op_sel_hi:[1,0,1]
    v_pk_fma_f32 v[58:59], v[58:59], v[104:105], v[104:105] op_sel:[0,0,1] op_sel_hi:[1,0,1]
    v_pk_fma_f32 v[60:61], v[60:61], v[108:109], v[108:109] op_sel:[0,0,1] op_sel_hi:[1,0,1]
    v_pk_fma_f32 v[62:63], v[62:63], v[108:109], v[108:109] op_sel:[0,0,1] op_sel_hi:[1,0,1]
    v_pk_mul_f32 v[56:57], v[56:57], v[192:193]
    v_pk_mul_f32 v[58:59], v[58:59], v[194:195]
    v_pk_mul_f32 v[60:61], v[60:61], v[196:197]
    v_pk_mul_f32 v[62:63], v[62:63], v[198:199]
    v_exp_f32 v56, v56
    v_exp_f32 v57, v57
    v_exp_f32 v58, v58
    v_exp_f32 v59, v59
    v_exp_f32 v60, v60
    v_exp_f32 v61, v61
    v_exp_f32 v62, v62
    v_exp_f32 v63, v63
    v_pk_mul_f32 v[208:209], v[208:209], v[192:193]
    v_pk_mul_f32 v[210:211], v[210:211], v[194:195]
    v_pk_mul_f32 v[212:213], v[212:213], v[196:197]
    v_pk_mul_f32 v[214:215], v[214:215], v[198:199]
    v_pk_fma_f32 v[56:57], v[56:57], v[106:107], v[106:107] op_sel:[0,0,0] op_sel_hi:[1,0,0]
    v_pk_fma_f32 v[58:59], v[58:59], v[106:107], v[106:107] op_sel:[0,0,0] op_sel_hi:[1,0,0]
    v_pk_fma_f32 v[60:61], v[60:61], v[110:111], v[110:111] op_sel:[0,0,0] op_sel_hi:[1,0,0]
    v_pk_fma_f32 v[62:63], v[62:63], v[110:111], v[110:111] op_sel:[0,0,0] op_sel_hi:[1,0,0]
    v_rcp_f32 v56, v56
    v_rcp_f32 v57, v57
    v_rcp_f32 v58, v58
    v_rcp_f32 v59, v59
    v_rcp_f32 v60, v60
    v_rcp_f32 v61, v61
    v_rcp_f32 v62, v62
    v_rcp_f32 v63, v63
    v_pk_mul_f32 v[208:209], v[208:209], v[56:57]
    v_pk_mul_f32 v[210:211], v[210:211], v[58:59]
    v_pk_mul_f32 v[212:213], v[212:213], v[60:61]
    v_pk_mul_f32 v[214:215], v[214:215], v[62:63]
    v_cvt_pk_bf16_f32 v128, v208, v209
    v_cvt_pk_bf16_f32 v130, v212, v213
    v_cvt_pk_bf16_f32 v129, v210, v211
    v_cvt_pk_bf16_f32 v131, v214, v215
    v_permlane16_swap_b32 v128, v130
    s_nop 0
    v_permlane16_swap_b32 v129, v131
    s_nop 0
    buffer_store_dwordx4 v[128:131], v6, s[44:47], s56 offen offset:0 sc1
    v_pk_mul_f32 v[56:57], v[200:201], v[200:201]
    v_pk_mul_f32 v[58:59], v[202:203], v[202:203]
    v_pk_mul_f32 v[60:61], v[204:205], v[204:205]
    v_pk_mul_f32 v[62:63], v[206:207], v[206:207]
    v_pk_fma_f32 v[56:57], v[56:57], v[112:113], v[112:113] op_sel:[0,0,1] op_sel_hi:[1,0,1]
    v_pk_fma_f32 v[58:59], v[58:59], v[112:113], v[112:113] op_sel:[0,0,1] op_sel_hi:[1,0,1]
    v_pk_fma_f32 v[60:61], v[60:61], v[116:117], v[116:117] op_sel:[0,0,1] op_sel_hi:[1,0,1]
    v_pk_fma_f32 v[62:63], v[62:63], v[116:117], v[116:117] op_sel:[0,0,1] op_sel_hi:[1,0,1]
    v_pk_mul_f32 v[56:57], v[56:57], v[200:201]
    v_pk_mul_f32 v[58:59], v[58:59], v[202:203]
    v_pk_mul_f32 v[60:61], v[60:61], v[204:205]
    v_pk_mul_f32 v[62:63], v[62:63], v[206:207]
    v_exp_f32 v56, v56
    v_exp_f32 v57, v57
    v_exp_f32 v58, v58
    v_exp_f32 v59, v59
    v_exp_f32 v60, v60
    v_exp_f32 v61, v61
    v_exp_f32 v62, v62
    v_exp_f32 v63, v63
    v_pk_mul_f32 v[216:217], v[216:217], v[200:201]
    v_pk_mul_f32 v[218:219], v[218:219], v[202:203]
    v_pk_mul_f32 v[220:221], v[220:221], v[204:205]
    v_pk_mul_f32 v[222:223], v[222:223], v[206:207]
    v_pk_fma_f32 v[56:57], v[56:57], v[114:115], v[114:115] op_sel:[0,0,0] op_sel_hi:[1,0,0]
    v_pk_fma_f32 v[58:59], v[58:59], v[114:115], v[114:115] op_sel:[0,0,0] op_sel_hi:[1,0,0]
    v_pk_fma_f32 v[60:61], v[60:61], v[118:119], v[118:119] op_sel:[0,0,0] op_sel_hi:[1,0,0]
    v_pk_fma_f32 v[62:63], v[62:63], v[118:119], v[118:119] op_sel:[0,0,0] op_sel_hi:[1,0,0]
    v_rcp_f32 v56, v56
    v_rcp_f32 v57, v57
    v_rcp_f32 v58, v58
    v_rcp_f32 v59, v59
    v_rcp_f32 v60, v60
    v_rcp_f32 v61, v61
    v_rcp_f32 v62, v62
    v_rcp_f32 v63, v63
    v_pk_mul_f32 v[216:217], v[216:217], v[56:57]
    v_pk_mul_f32 v[218:219], v[218:219], v[58:59]
    v_pk_mul_f32 v[220:221], v[220:221], v[60:61]
    v_pk_mul_f32 v[222:223], v[222:223], v[62:63]
    v_cvt_pk_bf16_f32 v132, v216, v217
    v_cvt_pk_bf16_f32 v134, v220, v221
    v_cvt_pk_bf16_f32 v133, v218, v219
    v_cvt_pk_bf16_f32 v135, v222, v223
    v_permlane16_swap_b32 v132, v134
    s_nop 0
    v_permlane16_swap_b32 v133, v135
    buffer_store_dwordx4 v[132:135], v6, s[44:47], s57 offen offset:0 sc1
    s_cmp_ge_u32 s14, 84
    s_cbranch_scc1 L_EPI_SHORT
    v_pk_mul_f32 v[56:57], v[224:225], v[224:225]
    v_pk_mul_f32 v[58:59], v[226:227], v[226:227]
    v_pk_mul_f32 v[60:61], v[228:229], v[228:229]
    v_pk_mul_f32 v[62:63], v[230:231], v[230:231]
    v_pk_fma_f32 v[56:57], v[56:57], v[104:105], v[104:105] op_sel:[0,0,1] op_sel_hi:[1,0,1]
    v_pk_fma_f32 v[58:59], v[58:59], v[104:105], v[104:105] op_sel:[0,0,1] op_sel_hi:[1,0,1]
    v_pk_fma_f32 v[60:61], v[60:61], v[108:109], v[108:109] op_sel:[0,0,1] op_sel_hi:[1,0,1]
    v_pk_fma_f32 v[62:63], v[62:63], v[108:109], v[108:109] op_sel:[0,0,1] op_sel_hi:[1,0,1]
    v_pk_mul_f32 v[56:57], v[56:57], v[224:225]
    v_pk_mul_f32 v[58:59], v[58:59], v[226:227]
    v_pk_mul_f32 v[60:61], v[60:61], v[228:229]
    v_pk_mul_f32 v[62:63], v[62:63], v[230:231]
    v_exp_f32 v56, v56
    v_exp_f32 v57, v57
    v_exp_f32 v58, v58
    v_exp_f32 v59, v59
    v_exp_f32 v60, v60
    v_exp_f32 v61, v61
    v_exp_f32 v62, v62
    v_exp_f32 v63, v63
    v_pk_mul_f32 v[240:241], v[240:241], v[224:225]
    v_pk_mul_f32 v[242:243], v[242:243], v[226:227]
    v_pk_mul_f32 v[244:245], v[244:245], v[228:229]
    v_pk_mul_f32 v[246:247], v[246:247], v[230:231]
    v_pk_fma_f32 v[56:57], v[56:57], v[106:107], v[106:107] op_sel:[0,0,0] op_sel_hi:[1,0,0]
    v_pk_fma_f32 v[58:59], v[58:59], v[106:107], v[106:107] op_sel:[0,0,0] op_sel_hi:[1,0,0]
    v_pk_fma_f32 v[60:61], v[60:61], v[110:111], v[110:111] op_sel:[0,0,0] op_sel_hi:[1,0,0]
    v_pk_fma_f32 v[62:63], v[62:63], v[110:111], v[110:111] op_sel:[0,0,0] op_sel_hi:[1,0,0]
    v_rcp_f32 v56, v56
    v_rcp_f32 v57, v57
    v_rcp_f32 v58, v58
    v_rcp_f32 v59, v59
    v_rcp_f32 v60, v60
    v_rcp_f32 v61, v61
    v_rcp_f32 v62, v62
    v_rcp_f32 v63, v63
    v_pk_mul_f32 v[240:241], v[240:241], v[56:57]
    v_pk_mul_f32 v[242:243], v[242:243], v[58:59]
    v_pk_mul_f32 v[244:245], v[244:245], v[60:61]
    v_pk_mul_f32 v[246:247], v[246:247], v[62:63]
    v_cvt_pk_bf16_f32 v128, v240, v241
    v_cvt_pk_bf16_f32 v130, v244, v245
    v_cvt_pk_bf16_f32 v129, v242, v243
    v_cvt_pk_bf16_f32 v131, v246, v247
    v_permlane16_swap_b32 v128, v130
    s_nop 0
    v_permlane16_swap_b32 v129, v131
    s_nop 0
    buffer_store_dwordx4 v[128:131], v6, s[44:47], s56 offen offset:1024 sc1
    v_pk_mul_f32 v[56:57], v[232:233], v[232:233]
    v_pk_mul_f32 v[58:59], v[234:235], v[234:235]
    v_pk_mul_f32 v[60:61], v[236:237], v[236:237]
    v_pk_mul_f32 v[62:63], v[238:239], v[238:239]
    v_pk_fma_f32 v[56:57], v[56:57], v[112:113], v[112:113] op_sel:[0,0,1] op_sel_hi:[1,0,1]
    v_pk_fma_f32 v[58:59], v[58:59], v[112:113], v[112:113] op_sel:[0,0,1] op_sel_hi:[1,0,1]
    v_pk_fma_f32 v[60:61], v[60:61], v[116:117], v[116:117] op_sel:[0,0,1] op_sel_hi:[1,0,1]
    v_pk_fma_f32 v[62:63], v[62:63], v[116:117], v[116:117] op_sel:[0,0,1] op_sel_hi:[1,0,1]
    v_pk_mul_f32 v[56:57], v[56:57], v[232:233]
    v_pk_mul_f32 v[58:59], v[58:59], v[234:235]
    v_pk_mul_f32 v[60:61], v[60:61], v[236:237]
    v_pk_mul_f32 v[62:63], v[62:63], v[238:239]
    v_exp_f32 v56, v56
    v_exp_f32 v57, v57
    v_exp_f32 v58, v58
    v_exp_f32 v59, v59
    v_exp_f32 v60, v60
    v_exp_f32 v61, v61
    v_exp_f32 v62, v62
    v_exp_f32 v63, v63
    v_pk_mul_f32 v[248:249], v[248:249], v[232:233]
    v_pk_mul_f32 v[250:251], v[250:251], v[234:235]
    v_pk_mul_f32 v[252:253], v[252:253], v[236:237]
    v_pk_mul_f32 v[254:255], v[254:255], v[238:239]
    v_pk_fma_f32 v[56:57], v[56:57], v[114:115], v[114:115] op_sel:[0,0,0] op_sel_hi:[1,0,0]
    v_pk_fma_f32 v[58:59], v[58:59], v[114:115], v[114:115] op_sel:[0,0,0] op_sel_hi:[1,0,0]
    v_pk_fma_f32 v[60:61], v[60:61], v[118:119], v[118:119] op_sel:[0,0,0] op_sel_hi:[1,0,0]
    v_pk_fma_f32 v[62:63], v[62:63], v[118:119], v[118:119] op_sel:[0,0,0] op_sel_hi:[1,0,0]
    v_rcp_f32 v56, v56
    v_rcp_f32 v57, v57
    v_rcp_f32 v58, v58
    v_rcp_f32 v59, v59
    v_rcp_f32 v60, v60
    v_rcp_f32 v61, v61
    v_rcp_f32 v62, v62
    v_rcp_f32 v63, v63
    v_pk_mul_f32 v[248:249], v[248:249], v[56:57]
    v_pk_mul_f32 v[250:251], v[250:251], v[58:59]
    v_pk_mul_f32 v[252:253], v[252:253], v[60:61]
    v_pk_mul_f32 v[254:255], v[254:255], v[62:63]
    v_cvt_pk_bf16_f32 v132, v248, v249
    v_cvt_pk_bf16_f32 v134, v252, v253
    v_cvt_pk_bf16_f32 v133, v250, v251
    v_cvt_pk_bf16_f32 v135, v254, v255
    v_permlane16_swap_b32 v132, v134
    s_nop 0
    v_permlane16_swap_b32 v133, v135
    buffer_store_dwordx4 v[132:135], v6, s[44:47], s57 offen offset:1024 sc1
L_EPI_SHORT:
L_EPI_DONE:
    s_setprio 0
L_G2:
    s_barrier
    s_add_u32 s56, s16, 32768
    s_add_u32 m0, s18, 131072
    s_nop 0
    buffer_load_dwordx4 v13, s[36:39], s56 offen lds
    s_add_u32 s56, s16, 81920
    s_add_u32 m0, s18, 49152
    s_nop 0
    buffer_load_dwordx4 v13, s[36:39], s56 offen lds
    s_add_u32 s56, s16, 131072
    s_add_u32 m0, s18, 139264
    s_nop 0
    buffer_load_dwordx4 v13, s[36:39], s56 offen lds
    s_add_u32 s56, s16, 180224
    s_add_u32 m0, s18, 57344
    s_nop 0
    buffer_load_dwordx4 v13, s[36:39], s56 offen lds
    s_add_u32 s56, s16, 229376
    s_add_u32 m0, s18, 147456
    s_nop 0
    buffer_load_dwordx4 v13, s[36:39], s56 offen lds
    s_add_u32 s56, s16, 278528
    s_add_u32 m0, s18, 155648
    s_nop 0
    buffer_load_dwordx4 v13, s[36:39], s56 offen lds
    buffer_load_dwordx4 v[156:159], v9, s[52:55], 0 offen sc1
    s_waitcnt vmcnt(7)
    s_barrier
    s_add_u32 s65, s20, 0
    s_lshr_b32 s56, s65, 3
    s_lshl_b32 s56, s56, 14
    s_and_b32 s66, s65, 7
    s_lshl_b32 s66, s66, 10
    s_add_u32 s56, s56, s66
    s_add_u32 s56, s56, 5808128
    buffer_load_dwordx4 v[64:67], v6, s[44:47], s56 offen sc1
    s_add_u32 s65, s20, 1
    s_lshr_b32 s56, s65, 3
    s_lshl_b32 s56, s56, 14
    s_and_b32 s66, s65, 7
    s_lshl_b32 s66, s66, 10
    s_add_u32 s56, s56, s66
    s_add_u32 s56, s56, 5808128
    buffer_load_dwordx4 v[68:71], v6, s[44:47], s56 offen sc1
    s_add_u32 s65, s20, 2
    s_lshr_b32 s56, s65, 3
    s_lshl_b32 s56, s56, 14
    s_and_b32 s66, s65, 7
    s_lshl_b32 s66, s66, 10
    s_add_u32 s56, s56, s66
    s_add_u32 s56, s56, 5808128
    buffer_load_dwordx4 v[72:75], v6, s[44:47], s56 offen sc1
    s_add_u32 s65, s20, 3
    s_lshr_b32 s56, s65, 3
    s_lshl_b32 s56, s56, 14
    s_and_b32 s66, s65, 7
    s_lshl_b32 s66, s66, 10
    s_add_u32 s56, s56, s66
    s_add_u32 s56, s56, 5808128
    buffer_load_dwordx4 v[76:79], v6, s[44:47], s56 offen sc1
    s_add_u32 s65, s20, 4
    s_lshr_b32 s56, s65, 3
    s_lshl_b32 s56, s56, 14
    s_and_b32 s66, s65, 7
    s_lshl_b32 s66, s66, 10
    s_add_u32 s56, s56, s66
    s_add_u32 s56, s56, 5808128
    buffer_load_dwordx4 v[80:83], v6, s[44:47], s56 offen sc1
    ds_read_b64_tr_b16 v[32:33], v8 offset:0
    ds_read_b64_tr_b16 v[34:35], v8 offset:512
    ds_read_b64_tr_b16 v[36:37], v10 offset:0
    ds_read_b64_tr_b16 v[38:39], v10 offset:512
    ds_read_b64_tr_b16 v[40:41], v11 offset:0
    ds_read_b64_tr_b16 v[42:43], v11 offset:512
    ds_read_b64_tr_b16 v[44:45], v12 offset:0
    ds_read_b64_tr_b16 v[46:47], v12 offset:512
    ds_read_b64_tr_b16 v[48:49], v8 offset:8192
    ds_read_b64_tr_b16 v[50:51], v8 offset:8704
    ds_read_b64_tr_b16 v[52:53], v10 offset:8192
    ds_read_b64_tr_b16 v[54:55], v10 offset:8704
    v_and_b32 v16, 31, v1
    v_and_b32 v17, 15, v1
    v_xor_b32 v18, v17, v3
    v_lshlrev_b32_e64 v18, 4, v18
    v_lshl_add_u32 v16, v16, 8, v18
    s_lshl_b32 s56, s11, 13
    s_lshl_b32 s57, s31, 16
    s_add_u32 s56, s56, s57
    v_add_u32 v224, s56, v16
    s_add_u32 s56, s18, 106496
    v_add_u32 v232, s56, v6
    v_xor_b32 v225, 32, v224
    v_xor_b32_e64 v226, 64, v224
    v_xor_b32 v227, 96, v224
    v_xor_b32 v228, 128, v224
    v_xor_b32 v229, 160, v224
    v_xor_b32 v230, 192, v224
    v_xor_b32 v231, 224, v224
    s_lshl_b32 s58, s11, 4
    v_add_u32 v16, s58, v17
    v_lshrrev_b32 v22, 4, v1
    s_lshl_b32 s58, s31, 2
    v_add_u32 v18, s58, v22
    v_lshlrev_b32 v18, 1, v18
    v_xor_b32 v18, v18, v17
    v_lshlrev_b32 v18, 4, v18
    v_and_b32_e64 v19, 31, v16
    v_lshl_add_u32 v18, v19, 8, v18
    s_lshr_b32 s58, s11, 1
    s_lshl_b32 s58, s58, 16
    v_add_u32 v18, s58, v18
    v_xor_b32 v19, 16, v18
    v_lshl_add_u32 v20, v22, 3, v4
    v_lshlrev_b32_e64 v20, 7, v20
    v_lshl_add_u32 v20, v5, 3, v20
    s_lshl_b32 s58, s31, 12
    s_lshl_b32 s59, s11, 5
    s_add_u32 s58, s58, s59
    s_add_u32 s58, s58, 106496
    v_add_u32 v20, s58, v20
    v_lshlrev_b32_e64 v21, 10, v16
    v_lshl_add_u32 v21, v22, 4, v21
    s_lshl_b32 s58, s8, 16
    s_lshl_b32 s59, s9, 7
    s_add_u32 s58, s58, s59
    s_lshl_b32 s59, s31, 6
    s_add_u32 s58, s58, s59
    s_mov_b32 s40, s26
    s_mov_b32 s41, s27
    s_mov_b32 s42, 0x200000
    s_mov_b32 s43, 0x20000
    s_waitcnt vmcnt(4) lgkmcnt(8)
L_HC0:
    v_xor_b32 v27, s30, v65
    v_xor_b32 v28, s30, v67
    v_min_u32 v27, v27, v28
    v_cmp_eq_u32 vcc, 0, v27
    s_cbranch_vccnz L_HR0
L_HC0_OK:
    v_mfma_f32_32x32x16_bf16 v[192:207], v[32:35], v[64:67], 0
    ds_read_b64_tr_b16 v[56:57], v11 offset:8192
    ds_read_b64_tr_b16 v[58:59], v11 offset:8704
    ds_read_b64_tr_b16 v[60:61], v12 offset:8192
    ds_read_b64_tr_b16 v[62:63], v12 offset:8704
    v_mfma_f32_32x32x16_bf16 v[208:223], v[36:39], v[64:67], 0
    s_add_u32 s65, s20, 5
    s_lshr_b32 s56, s65, 3
    s_lshl_b32 s56, s56, 14
    s_and_b32 s66, s65, 7
    s_lshl_b32 s66, s66, 10
    s_add_u32 s56, s56, s66
    s_add_u32 s56, s56, 5808128
    buffer_load_dwordx4 v[84:87], v6, s[44:47], s56 offen sc1
    s_waitcnt vmcnt(4) lgkmcnt(8)
L_HC1:
    v_xor_b32 v27, s30, v69
    v_xor_b32 v28, s30, v71
    v_min_u32 v27, v27, v28
    v_cmp_eq_u32 vcc, 0, v27
    s_cbranch_vccnz L_HR1
L_HC1_OK:
    v_mfma_f32_32x32x16_bf16 v[192:207], v[40:43], v[68:71], v[192:207]
    ds_read_b64_tr_b16 v[32:33], v11 offset:16384
    ds_read_b64_tr_b16 v[34:35], v11 offset:16896
    ds_read_b64_tr_b16 v[36:37], v12 offset:16384
    ds_read_b64_tr_b16 v[38:39], v12 offset:16896
    v_mfma_f32_32x32x16_bf16 v[208:223], v[44:47], v[68:71], v[208:223]
    s_add_u32 s65, s20, 6
    s_lshr_b32 s56, s65, 3
    s_lshl_b32 s56, s56, 14
    s_and_b32 s66, s65, 7
    s_lshl_b32 s66, s66, 10
    s_add_u32 s56, s56, s66
    s_add_u32 s56, s56, 5808128
    buffer_load_dwordx4 v[88:91], v6, s[44:47], s56 offen sc1
    s_waitcnt vmcnt(4) lgkmcnt(8)
L_HC2:
    v_xor_b32 v27, s30, v73
    v_xor_b32 v28, s30, v75
    v_min_u32 v27, v27, v28
    v_cmp_eq_u32 vcc, 0, v27
    s_cbranch_vccnz L_HR2
L_HC2_OK:
    v_mfma_f32_32x32x16_bf16 v[192:207], v[48:51], v[72:75], v[192:207]
    ds_read_b64_tr_b16 v[40:41], v8 offset:16384
    ds_read_b64_tr_b16 v[42:43], v8 offset:16896
    ds_read_b64_tr_b16 v[44:45], v10 offset:16384
    ds_read_b64_tr_b16 v[46:47], v10 offset:16896
    v_mfma_f32_32x32x16_bf16 v[208:223], v[52:55], v[72:75], v[208:223]
    s_add_u32 s56, s4, 0
    buffer_load_dwordx4 v[92:95], v155, s[44:47], s56 offen sc1
    s_waitcnt vmcnt(4) lgkmcnt(8)
L_HC3:
    v_xor_b32 v27, s30, v77
    v_xor_b32 v28, s30, v79
    v_min_u32 v27, v27, v28
    v_cmp_eq_u32 vcc, 0, v27
    s_cbranch_vccnz L_HR3
L_HC3_OK:
    v_mfma_f32_32x32x16_bf16 v[192:207], v[56:59], v[76:79], v[192:207]
    ds_read_b64_tr_b16 v[48:49], v11 offset:24576
    ds_read_b64_tr_b16 v[50:51], v11 offset:25088
    ds_read_b64_tr_b16 v[52:53], v12 offset:24576
    ds_read_b64_tr_b16 v[54:55], v12 offset:25088
    v_mfma_f32_32x32x16_bf16 v[208:223], v[60:63], v[76:79], v[208:223]
    s_add_u32 s56, s4, 2048
    buffer_load_dwordx4 v[96:99], v155, s[44:47], s56 offen sc1
    s_waitcnt vmcnt(4) lgkmcnt(8)
L_HC4:
    v_xor_b32 v27, s30, v81
    v_xor_b32 v28, s30, v83
    v_min_u32 v27, v27, v28
    v_cmp_eq_u32 vcc, 0, v27
    s_cbranch_vccnz L_HR4
L_HC4_OK:
    v_mfma_f32_32x32x16_bf16 v[192:207], v[32:35], v[80:83], v[192:207]
    ds_read_b64_tr_b16 v[56:57], v8 offset:24576
    ds_read_b64_tr_b16 v[58:59], v8 offset:25088
    ds_read_b64_tr_b16 v[60:61], v10 offset:24576
    ds_read_b64_tr_b16 v[62:63], v10 offset:25088
    v_mfma_f32_32x32x16_bf16 v[208:223], v[36:39], v[80:83], v[208:223]
    s_add_u32 s56, s4, 4096
    buffer_load_dwordx4 v[100:103], v155, s[44:47], s56 offen sc1
    s_waitcnt vmcnt(4) lgkmcnt(8)
L_HC5:
    v_xor_b32 v27, s30, v85
    v_xor_b32 v28, s30, v87
    v_min_u32 v27, v27, v28
    v_cmp_eq_u32 vcc, 0, v27
    s_cbranch_vccnz L_HR5
L_HC5_OK:
    v_mfma_f32_32x32x16_bf16 v[192:207], v[40:43], v[84:87], v[192:207]
    ds_read_b64_tr_b16 v[32:33], v11 offset:32768
    ds_read_b64_tr_b16 v[34:35], v11 offset:33280
    ds_read_b64_tr_b16 v[36:37], v12 offset:32768
    ds_read_b64_tr_b16 v[38:39], v12 offset:33280
    v_mfma_f32_32x32x16_bf16 v[208:223], v[44:47], v[84:87], v[208:223]
    s_add_u32 s56, s4, 6144
    buffer_load_dwordx4 v[104:107], v155, s[44:47], s56 offen sc1
    s_waitcnt vmcnt(4) lgkmcnt(8)
L_HC6:
    v_xor_b32 v27, s30, v89
    v_xor_b32 v28, s30, v91
    v_min_u32 v27, v27, v28
    v_cmp_eq_u32 vcc, 0, v27
    s_cbranch_vccnz L_HR6
L_HC6_OK:
    v_mfma_f32_32x32x16_bf16 v[192:207], v[48:51], v[88:91], v[192:207]
    ds_read_b64_tr_b16 v[40:41], v11 offset:40960
    ds_read_b64_tr_b16 v[42:43], v11 offset:41472
    ds_read_b64_tr_b16 v[44:45], v12 offset:40960
    ds_read_b64_tr_b16 v[46:47], v12 offset:41472
    v_mfma_f32_32x32x16_bf16 v[208:223], v[52:55], v[88:91], v[208:223]
    s_add_u32 s56, s4, 8192
    buffer_load_dwordx4 v[108:111], v155, s[44:47], s56 offen sc1
    s_waitcnt vmcnt(4) lgkmcnt(8)
L_HC7:
    v_xor_b32 v27, s30, v93
    v_xor_b32 v28, s30, v95
    v_min_u32 v27, v27, v28
    v_cmp_eq_u32 vcc, 0, v27
    s_cbranch_vccnz L_HR7
L_HC7_OK:
    v_mfma_f32_32x32x16_bf16 v[192:207], v[56:59], v[92:95], v[192:207]
    ds_read_b64_tr_b16 v[48:49], v8 offset:32768
    ds_read_b64_tr_b16 v[50:51], v8 offset:33280
    ds_read_b64_tr_b16 v[52:53], v10 offset:32768
    ds_read_b64_tr_b16 v[54:55], v10 offset:33280
    v_mfma_f32_32x32x16_bf16 v[208:223], v[60:63], v[92:95], v[208:223]
    s_add_u32 s56, s4, 10240
    buffer_load_dwordx4 v[112:115], v155, s[44:47], s56 offen sc1
    s_waitcnt vmcnt(4) lgkmcnt(8)
L_HC8:
    v_xor_b32 v27, s30, v97
    v_xor_b32 v28, s30, v99
    v_min_u32 v27, v27, v28
    v_cmp_eq_u32 vcc, 0, v27
    s_cbranch_vccnz L_HR8
L_HC8_OK:
    v_mfma_f32_32x32x16_bf16 v[192:207], v[32:35], v[96:99], v[192:207]
    ds_read_b64_tr_b16 v[56:57], v11 offset:49152
    ds_read_b64_tr_b16 v[58:59], v11 offset:49664
    ds_read_b64_tr_b16 v[60:61], v12 offset:49152
    ds_read_b64_tr_b16 v[62:63], v12 offset:49664
    v_mfma_f32_32x32x16_bf16 v[208:223], v[36:39], v[96:99], v[208:223]
    s_add_u32 s56, s4, 12288
    buffer_load_dwordx4 v[116:119], v155, s[44:47], s56 offen sc1
    s_waitcnt vmcnt(4) lgkmcnt(8)
L_HC9:
    v_xor_b32 v27, s30, v101
    v_xor_b32 v28, s30, v103
    v_min_u32 v27, v27, v28
    v_cmp_eq_u32 vcc, 0, v27
    s_cbranch_vccnz L_HR9
L_HC9_OK:
    v_mfma_f32_32x32x16_bf16 v[192:207], v[40:43], v[100:103], v[192:207]
    ds_read_b64_tr_b16 v[32:33], v8 offset:40960
    ds_read_b64_tr_b16 v[34:35], v8 offset:41472
    ds_read_b64_tr_b16 v[36:37], v10 offset:40960
    ds_read_b64_tr_b16 v[38:39], v10 offset:41472
    v_mfma_f32_32x32x16_bf16 v[208:223], v[44:47], v[100:103], v[208:223]
    s_add_u32 s56, s4, 1024
    buffer_load_dwordx4 v[120:123], v155, s[44:47], s56 offen sc1
    s_waitcnt vmcnt(4) lgkmcnt(8)
L_HC10:
    v_xor_b32 v27, s30, v105
    v_xor_b32 v28, s30, v107
    v_min_u32 v27, v27, v28
    v_cmp_eq_u32 vcc, 0, v27
    s_cbranch_vccnz L_HR10
L_HC10_OK:
    s_barrier
    v_mfma_f32_32x32x16_bf16 v[192:207], v[48:51], v[104:107], v[192:207]
    ds_read_b64_tr_b16 v[40:41], v11 offset:57344
    ds_read_b64_tr_b16 v[42:43], v11 offset:57856
    ds_read_b64_tr_b16 v[44:45], v12 offset:57344
    ds_read_b64_tr_b16 v[46:47], v12 offset:57856
    v_mfma_f32_32x32x16_bf16 v[208:223], v[52:55], v[104:107], v[208:223]
    s_add_u32 s56, s4, 3072
    buffer_load_dwordx4 v[124:127], v155, s[44:47], s56 offen sc1
    s_add_u32 s56, s16, 327680
    s_add_u32 m0, s18, 0
    s_nop 0
    buffer_load_dwordx4 v13, s[36:39], s56 offen lds
    s_waitcnt vmcnt(5) lgkmcnt(8)
L_HC11:
    v_xor_b32 v27, s30, v109
    v_xor_b32 v28, s30, v111
    v_min_u32 v27, v27, v28
    v_cmp_eq_u32 vcc, 0, v27
    s_cbranch_vccnz L_HR11
L_HC11_OK:
    v_mfma_f32_32x32x16_bf16 v[192:207], v[56:59], v[108:111], v[192:207]
    ds_read_b64_tr_b16 v[48:49], v14 offset:0
    ds_read_b64_tr_b16 v[50:51], v14 offset:512
    ds_read_b64_tr_b16 v[52:53], v154 offset:0
    ds_read_b64_tr_b16 v[54:55], v154 offset:512
    v_mfma_f32_32x32x16_bf16 v[208:223], v[60:63], v[108:111], v[208:223]
    s_add_u32 s56, s4, 5120
    buffer_load_dwordx4 v[128:131], v155, s[44:47], s56 offen sc1
    s_mov_b32 s56, s17
    s_add_u32 m0, s18, 65536
    s_nop 0
    buffer_load_dwordx4 v13, s[36:39], s56 offen lds
    s_waitcnt vmcnt(6) lgkmcnt(8)
L_HC12:
    v_xor_b32 v27, s30, v113
    v_xor_b32 v28, s30, v115
    v_min_u32 v27, v27, v28
    v_cmp_eq_u32 vcc, 0, v27
    s_cbranch_vccnz L_HR12
L_HC12_OK:
    v_mfma_f32_32x32x16_bf16 v[192:207], v[32:35], v[112:115], v[192:207]
    ds_read_b64_tr_b16 v[56:57], v8 offset:49152
    ds_read_b64_tr_b16 v[58:59], v8 offset:49664
    ds_read_b64_tr_b16 v[60:61], v10 offset:49152
    ds_read_b64_tr_b16 v[62:63], v10 offset:49664
    v_mfma_f32_32x32x16_bf16 v[208:223], v[36:39], v[112:115], v[208:223]
    s_add_u32 s56, s4, 7168
    buffer_load_dwordx4 v[132:135], v155, s[44:47], s56 offen sc1
    s_waitcnt vmcnt(6) lgkmcnt(8)
L_HC13:
    v_xor_b32 v27, s30, v117
    v_xor_b32 v28, s30, v119
    v_min_u32 v27, v27, v28
    v_cmp_eq_u32 vcc, 0, v27
    s_cbranch_vccnz L_HR13
L_HC13_OK:
    v_mfma_f32_32x32x16_bf16 v[192:207], v[40:43], v[116:119], v[192:207]
    ds_read_b64_tr_b16 v[32:33], v14 offset:8192
    ds_read_b64_tr_b16 v[34:35], v14 offset:8704
    ds_read_b64_tr_b16 v[36:37], v154 offset:8192
    ds_read_b64_tr_b16 v[38:39], v154 offset:8704
    v_mfma_f32_32x32x16_bf16 v[208:223], v[44:47], v[116:119], v[208:223]
    s_add_u32 s56, s4, 9216
    buffer_load_dwordx4 v[136:139], v155, s[44:47], s56 offen sc1
    s_waitcnt vmcnt(6) lgkmcnt(8)
L_HC14:
    v_xor_b32 v27, s30, v121
    v_xor_b32 v28, s30, v123
    v_min_u32 v27, v27, v28
    v_cmp_eq_u32 vcc, 0, v27
    s_cbranch_vccnz L_HR14
L_HC14_OK:
    v_mfma_f32_32x32x16_bf16 v[192:207], v[48:51], v[120:123], v[192:207]
    ds_read_b64_tr_b16 v[40:41], v8 offset:57344
    ds_read_b64_tr_b16 v[42:43], v8 offset:57856
    ds_read_b64_tr_b16 v[44:45], v10 offset:57344
    ds_read_b64_tr_b16 v[46:47], v10 offset:57856
    v_mfma_f32_32x32x16_bf16 v[208:223], v[52:55], v[120:123], v[208:223]
    s_add_u32 s56, s4, 11264
    buffer_load_dwordx4 v[140:143], v155, s[44:47], s56 offen sc1
    s_waitcnt vmcnt(6) lgkmcnt(8)
L_HC15:
    v_xor_b32 v27, s30, v125
    v_xor_b32 v28, s30, v127
    v_min_u32 v27, v27, v28
    v_cmp_eq_u32 vcc, 0, v27
    s_cbranch_vccnz L_HR15
L_HC15_OK:
    v_mfma_f32_32x32x16_bf16 v[192:207], v[56:59], v[124:127], v[192:207]
    ds_read_b64_tr_b16 v[48:49], v14 offset:16384
    ds_read_b64_tr_b16 v[50:51], v14 offset:16896
    ds_read_b64_tr_b16 v[52:53], v154 offset:16384
    ds_read_b64_tr_b16 v[54:55], v154 offset:16896
    v_mfma_f32_32x32x16_bf16 v[208:223], v[60:63], v[124:127], v[208:223]
    s_add_u32 s56, s4, 13312
    buffer_load_dwordx4 v[144:147], v155, s[44:47], s56 offen sc1
    s_waitcnt vmcnt(4) lgkmcnt(8)
L_HC16:
    v_xor_b32 v27, s30, v129
    v_xor_b32 v28, s30, v131
    v_min_u32 v27, v27, v28
    v_cmp_eq_u32 vcc, 0, v27
    s_cbranch_vccnz L_HR16
L_HC16_OK:
    s_barrier
    v_mfma_f32_32x32x16_bf16 v[192:207], v[32:35], v[128:131], v[192:207]
    ds_read_b64_tr_b16 v[56:57], v14 offset:24576
    ds_read_b64_tr_b16 v[58:59], v14 offset:25088
    ds_read_b64_tr_b16 v[60:61], v154 offset:24576
    ds_read_b64_tr_b16 v[62:63], v154 offset:25088
    v_mfma_f32_32x32x16_bf16 v[208:223], v[36:39], v[128:131], v[208:223]
    buffer_load_dwordx4 v[148:151], v155, s[44:47], s5 offen sc1
    s_waitcnt vmcnt(4) lgkmcnt(8)
L_HC17:
    v_xor_b32 v27, s30, v133
    v_xor_b32 v28, s30, v135
    v_min_u32 v27, v27, v28
    v_cmp_eq_u32 vcc, 0, v27
    s_cbranch_vccnz L_HR17
L_HC17_OK:
    v_mfma_f32_32x32x16_bf16 v[192:207], v[40:43], v[132:135], v[192:207]
    ds_read_b64_tr_b16 v[32:33], v8 offset:0
    ds_read_b64_tr_b16 v[34:35], v8 offset:512
    ds_read_b64_tr_b16 v[36:37], v10 offset:0
    ds_read_b64_tr_b16 v[38:39], v10 offset:512
    v_mfma_f32_32x32x16_bf16 v[208:223], v[44:47], v[132:135], v[208:223]
    s_waitcnt vmcnt(3) lgkmcnt(8)
L_HC18:
    v_xor_b32 v27, s30, v137
    v_xor_b32 v28, s30, v139
    v_min_u32 v27, v27, v28
    v_cmp_eq_u32 vcc, 0, v27
    s_cbranch_vccnz L_HR18
L_HC18_OK:
    v_mfma_f32_32x32x16_bf16 v[192:207], v[48:51], v[136:139], v[192:207]
    ds_read_b64_tr_b16 v[40:41], v11 offset:0
    ds_read_b64_tr_b16 v[42:43], v11 offset:512
    ds_read_b64_tr_b16 v[44:45], v12 offset:0
    ds_read_b64_tr_b16 v[46:47], v12 offset:512
    v_mfma_f32_32x32x16_bf16 v[208:223], v[52:55], v[136:139], v[208:223]
L_HQC:
    v_xor_b32 v27, s30, v157
    v_xor_b32 v28, s30, v159
    v_min_u32 v27, v27, v28
    v_cmp_eq_u32 vcc, 0, v27
    s_cbranch_vccz L_HQOK
    s_cmp_eq_u32 s19, 0
    s_cbranch_scc1 L_HQOK
    s_sub_u32 s19, s19, 1
    buffer_load_dwordx4 v[156:159], v9, s[52:55], 0 offen sc1
    s_waitcnt vmcnt(0)
    s_branch L_HQC
L_HQOK:
    ds_write_b128 v232, v[156:159]
    s_waitcnt vmcnt(2) lgkmcnt(8)
L_HC19:
    v_xor_b32 v27, s30, v141
    v_xor_b32 v28, s30, v143
    v_min_u32 v27, v27, v28
    v_cmp_eq_u32 vcc, 0, v27
    s_cbranch_vccnz L_HR19
L_HC19_OK:
    v_mfma_f32_32x32x16_bf16 v[192:207], v[56:59], v[140:143], v[192:207]
    v_mfma_f32_32x32x16_bf16 v[208:223], v[60:63], v[140:143], v[208:223]
    s_waitcnt vmcnt(1) lgkmcnt(4)
L_HC20:
    v_xor_b32 v27, s30, v145
    v_xor_b32 v28, s30, v147
    v_min_u32 v27, v27, v28
    v_cmp_eq_u32 vcc, 0, v27
    s_cbranch_vccnz L_HR20
L_HC20_OK:
    v_mfma_f32_32x32x16_bf16 v[192:207], v[32:35], v[144:147], v[192:207]
    v_mfma_f32_32x32x16_bf16 v[208:223], v[36:39], v[144:147], v[208:223]
    s_cmp_ge_u32 s11, 2
    s_cbranch_scc1 L_RED
    s_waitcnt vmcnt(0) lgkmcnt(0)
L_HC21:
    v_xor_b32 v27, s30, v149
    v_xor_b32 v28, s30, v151
    v_min_u32 v27, v27, v28
    v_cmp_eq_u32 vcc, 0, v27
    s_cbranch_vccnz L_HR21
L_HC21_OK:
    v_mfma_f32_32x32x16_bf16 v[192:207], v[40:43], v[148:151], v[192:207]
    v_mfma_f32_32x32x16_bf16 v[208:223], v[44:47], v[148:151], v[208:223]
L_RED:
    s_nop 7
    s_nop 2
    ds_write_b128 v224, v[192:195] offset:8192
    ds_write_b128 v225, v[196:199] offset:8192
    ds_write_b128 v226, v[200:203] offset:8192
    ds_write_b128 v227, v[204:207] offset:8192
    ds_write_b128 v228, v[208:211] offset:8192
    ds_write_b128 v229, v[212:215] offset:8192
    ds_write_b128 v230, v[216:219] offset:8192
    ds_write_b128 v231, v[220:223] offset:8192
    s_waitcnt lgkmcnt(0)
    s_barrier
    ds_read_b128 v[24:27], v18 offset:8192
    ds_read_b128 v[28:31], v19 offset:8192
    ds_read_b128 v[32:35], v18 offset:16384
    ds_read_b128 v[36:39], v19 offset:16384
    ds_read_b128 v[40:43], v18 offset:24576
    ds_read_b128 v[44:47], v19 offset:24576
    ds_read_b128 v[48:51], v18 offset:32768
    ds_read_b128 v[52:55], v19 offset:32768
    ds_read_b64_tr_b16 v[56:57], v20
    ds_read_b64_tr_b16 v[58:59], v20 offset:512
    s_waitcnt lgkmcnt(6)
    v_pk_add_f32 v[24:25], v[24:25], v[32:33]
    v_pk_add_f32 v[26:27], v[26:27], v[34:35]
    v_pk_add_f32 v[28:29], v[28:29], v[36:37]
    v_pk_add_f32 v[30:31], v[30:31], v[38:39]
    s_waitcnt lgkmcnt(2)
    v_pk_add_f32 v[40:41], v[40:41], v[48:49]
    v_pk_add_f32 v[42:43], v[42:43], v[50:51]
    v_pk_add_f32 v[44:45], v[44:45], v[52:53]
    v_pk_add_f32 v[46:47], v[46:47], v[54:55]
    v_pk_add_f32 v[24:25], v[24:25], v[40:41]
    v_pk_add_f32 v[26:27], v[26:27], v[42:43]
    v_pk_add_f32 v[28:29], v[28:29], v[44:45]
    v_pk_add_f32 v[30:31], v[30:31], v[46:47]
    s_waitcnt lgkmcnt(0)
    v_cvt_pk_bf16_f32 v40, v24, v25
    v_lshlrev_b32 v48, 16, v56
    v_and_b32 v49, 0xffff0000, v56
    v_cvt_pk_bf16_f32 v42, v26, v27
    v_lshlrev_b32_e64 v50, 16, v57
    v_and_b32 v51, 0xffff0000, v57
    v_cvt_pk_bf16_f32 v44, v28, v29
    v_lshlrev_b32_e64 v52, 16, v58
    v_and_b32 v53, 0xffff0000, v58
    v_cvt_pk_bf16_f32 v46, v30, v31
    v_lshlrev_b32_e64 v54, 16, v59
    v_and_b32 v55, 0xffff0000, v59
    v_and_b32 v41, 0xffff0000, v40
    v_lshlrev_b32_e64 v40, 16, v40
    v_and_b32 v43, 0xffff0000, v42
    v_lshlrev_b32_e64 v42, 16, v42
    v_and_b32 v45, 0xffff0000, v44
    v_lshlrev_b32_e64 v44, 16, v44
    v_and_b32 v47, 0xffff0000, v46
    v_lshlrev_b32_e64 v46, 16, v46
    v_pk_add_f32 v[40:41], v[40:41], v[48:49]
    v_pk_add_f32 v[42:43], v[42:43], v[50:51]
    v_pk_add_f32 v[44:45], v[44:45], v[52:53]
    v_pk_add_f32 v[46:47], v[46:47], v[54:55]
    v_cvt_pk_bf16_f32 v60, v40, v41
    v_cvt_pk_bf16_f32 v61, v42, v43
    v_cvt_pk_bf16_f32 v62, v44, v45
    v_cvt_pk_bf16_f32 v63, v46, v47
    buffer_store_dwordx4 v[60:63], v21, s[40:43], s58 offen
    s_endpgm
L_HR0:
    s_cmp_eq_u32 s19, 0
    s_cbranch_scc1 L_HC0_OK
    s_sub_u32 s19, s19, 1
    s_sleep 2
    s_add_u32 s65, s20, 0
    s_lshr_b32 s56, s65, 3
    s_lshl_b32 s56, s56, 14
    s_and_b32 s66, s65, 7
    s_lshl_b32 s66, s66, 10
    s_add_u32 s56, s56, s66
    s_add_u32 s56, s56, 5808128
    buffer_load_dwordx4 v[64:67], v6, s[44:47], s56 offen sc1
    s_waitcnt vmcnt(0)
    s_branch L_HC0
L_HR1:
    s_cmp_eq_u32 s19, 0
    s_cbranch_scc1 L_HC1_OK
    s_sub_u32 s19, s19, 1
    s_sleep 2
    s_add_u32 s65, s20, 1
    s_lshr_b32 s56, s65, 3
    s_lshl_b32 s56, s56, 14
    s_and_b32 s66, s65, 7
    s_lshl_b32 s66, s66, 10
    s_add_u32 s56, s56, s66
    s_add_u32 s56, s56, 5808128
    buffer_load_dwordx4 v[68:71], v6, s[44:47], s56 offen sc1
    s_waitcnt vmcnt(0)
    s_branch L_HC1
L_HR2:
    s_cmp_eq_u32 s19, 0
    s_cbranch_scc1 L_HC2_OK
    s_sub_u32 s19, s19, 1
    s_sleep 2
    s_add_u32 s65, s20, 2
    s_lshr_b32 s56, s65, 3
    s_lshl_b32 s56, s56, 14
    s_and_b32 s66, s65, 7
    s_lshl_b32 s66, s66, 10
    s_add_u32 s56, s56, s66
    s_add_u32 s56, s56, 5808128
    buffer_load_dwordx4 v[72:75], v6, s[44:47], s56 offen sc1
    s_waitcnt vmcnt(0)
    s_branch L_HC2
L_HR3:
    s_cmp_eq_u32 s19, 0
    s_cbranch_scc1 L_HC3_OK
    s_sub_u32 s19, s19, 1
    s_sleep 2
    s_add_u32 s65, s20, 3
    s_lshr_b32 s56, s65, 3
    s_lshl_b32 s56, s56, 14
    s_and_b32 s66, s65, 7
    s_lshl_b32 s66, s66, 10
    s_add_u32 s56, s56, s66
    s_add_u32 s56, s56, 5808128
    buffer_load_dwordx4 v[76:79], v6, s[44:47], s56 offen sc1
    s_waitcnt vmcnt(0)
    s_branch L_HC3
L_HR4:
    s_cmp_eq_u32 s19, 0
    s_cbranch_scc1 L_HC4_OK
    s_sub_u32 s19, s19, 1
    s_sleep 2
    s_add_u32 s65, s20, 4
    s_lshr_b32 s56, s65, 3
    s_lshl_b32 s56, s56, 14
    s_and_b32 s66, s65, 7
    s_lshl_b32 s66, s66, 10
    s_add_u32 s56, s56, s66
    s_add_u32 s56, s56, 5808128
    buffer_load_dwordx4 v[80:83], v6, s[44:47], s56 offen sc1
    s_waitcnt vmcnt(0)
    s_branch L_HC4
L_HR5:
    s_cmp_eq_u32 s19, 0
    s_cbranch_scc1 L_HC5_OK
    s_sub_u32 s19, s19, 1
    s_sleep 2
    s_add_u32 s65, s20, 5
    s_lshr_b32 s56, s65, 3
    s_lshl_b32 s56, s56, 14
    s_and_b32 s66, s65, 7
    s_lshl_b32 s66, s66, 10
    s_add_u32 s56, s56, s66
    s_add_u32 s56, s56, 5808128
    buffer_load_dwordx4 v[84:87], v6, s[44:47], s56 offen sc1
    s_waitcnt vmcnt(0)
    s_branch L_HC5
L_HR6:
    s_cmp_eq_u32 s19, 0
    s_cbranch_scc1 L_HC6_OK
    s_sub_u32 s19, s19, 1
    s_sleep 2
    s_add_u32 s65, s20, 6
    s_lshr_b32 s56, s65, 3
    s_lshl_b32 s56, s56, 14
    s_and_b32 s66, s65, 7
    s_lshl_b32 s66, s66, 10
    s_add_u32 s56, s56, s66
    s_add_u32 s56, s56, 5808128
    buffer_load_dwordx4 v[88:91], v6, s[44:47], s56 offen sc1
    s_waitcnt vmcnt(0)
    s_branch L_HC6
L_HR7:
    s_cmp_eq_u32 s19, 0
    s_cbranch_scc1 L_HC7_OK
    s_sub_u32 s19, s19, 1
    s_sleep 2
    s_add_u32 s56, s4, 0
    buffer_load_dwordx4 v[92:95], v155, s[44:47], s56 offen sc1
    s_waitcnt vmcnt(0)
    s_branch L_HC7
L_HR8:
    s_cmp_eq_u32 s19, 0
    s_cbranch_scc1 L_HC8_OK
    s_sub_u32 s19, s19, 1
    s_sleep 2
    s_add_u32 s56, s4, 2048
    buffer_load_dwordx4 v[96:99], v155, s[44:47], s56 offen sc1
    s_waitcnt vmcnt(0)
    s_branch L_HC8
L_HR9:
    s_cmp_eq_u32 s19, 0
    s_cbranch_scc1 L_HC9_OK
    s_sub_u32 s19, s19, 1
    s_sleep 2
    s_add_u32 s56, s4, 4096
    buffer_load_dwordx4 v[100:103], v155, s[44:47], s56 offen sc1
    s_waitcnt vmcnt(0)
    s_branch L_HC9
L_HR10:
    s_cmp_eq_u32 s19, 0
    s_cbranch_scc1 L_HC10_OK
    s_sub_u32 s19, s19, 1
    s_sleep 2
    s_add_u32 s56, s4, 6144
    buffer_load_dwordx4 v[104:107], v155, s[44:47], s56 offen sc1
    s_waitcnt vmcnt(0)
    s_branch L_HC10
L_HR11:
    s_cmp_eq_u32 s19, 0
    s_cbranch_scc1 L_HC11_OK
    s_sub_u32 s19, s19, 1
    s_sleep 2
    s_add_u32 s56, s4, 8192
    buffer_load_dwordx4 v[108:111], v155, s[44:47], s56 offen sc1
    s_waitcnt vmcnt(0)
    s_branch L_HC11
L_HR12:
    s_cmp_eq_u32 s19, 0
    s_cbranch_scc1 L_HC12_OK
    s_sub_u32 s19, s19, 1
    s_sleep 2
    s_add_u32 s56, s4, 10240
    buffer_load_dwordx4 v[112:115], v155, s[44:47], s56 offen sc1
    s_waitcnt vmcnt(0)
    s_branch L_HC12
L_HR13:
    s_cmp_eq_u32 s19, 0
    s_cbranch_scc1 L_HC13_OK
    s_sub_u32 s19, s19, 1
    s_sleep 2
    s_add_u32 s56, s4, 12288
    buffer_load_dwordx4 v[116:119], v155, s[44:47], s56 offen sc1
    s_waitcnt vmcnt(0)
    s_branch L_HC13
L_HR14:
    s_cmp_eq_u32 s19, 0
    s_cbranch_scc1 L_HC14_OK
    s_sub_u32 s19, s19, 1
    s_sleep 2
    s_add_u32 s56, s4, 1024
    buffer_load_dwordx4 v[120:123], v155, s[44:47], s56 offen sc1
    s_waitcnt vmcnt(0)
    s_branch L_HC14
L_HR15:
    s_cmp_eq_u32 s19, 0
    s_cbranch_scc1 L_HC15_OK
    s_sub_u32 s19, s19, 1
    s_sleep 2
    s_add_u32 s56, s4, 3072
    buffer_load_dwordx4 v[124:127], v155, s[44:47], s56 offen sc1
    s_waitcnt vmcnt(0)
    s_branch L_HC15
L_HR16:
    s_cmp_eq_u32 s19, 0
    s_cbranch_scc1 L_HC16_OK
    s_sub_u32 s19, s19, 1
    s_sleep 2
    s_add_u32 s56, s4, 5120
    buffer_load_dwordx4 v[128:131], v155, s[44:47], s56 offen sc1
    s_waitcnt vmcnt(0)
    s_branch L_HC16
L_HR17:
    s_cmp_eq_u32 s19, 0
    s_cbranch_scc1 L_HC17_OK
    s_sub_u32 s19, s19, 1
    s_sleep 2
    s_add_u32 s56, s4, 7168
    buffer_load_dwordx4 v[132:135], v155, s[44:47], s56 offen sc1
    s_waitcnt vmcnt(0)
    s_branch L_HC17
L_HR18:
    s_cmp_eq_u32 s19, 0
    s_cbranch_scc1 L_HC18_OK
    s_sub_u32 s19, s19, 1
    s_sleep 2
    s_add_u32 s56, s4, 9216
    buffer_load_dwordx4 v[136:139], v155, s[44:47], s56 offen sc1
    s_waitcnt vmcnt(0)
    s_branch L_HC18
L_HR19:
    s_cmp_eq_u32 s19, 0
    s_cbranch_scc1 L_HC19_OK
    s_sub_u32 s19, s19, 1
    s_sleep 2
    s_add_u32 s56, s4, 11264
    buffer_load_dwordx4 v[140:143], v155, s[44:47], s56 offen sc1
    s_waitcnt vmcnt(0)
    s_branch L_HC19
L_HR20:
    s_cmp_eq_u32 s19, 0
    s_cbranch_scc1 L_HC20_OK
    s_sub_u32 s19, s19, 1
    s_sleep 2
    s_add_u32 s56, s4, 13312
    buffer_load_dwordx4 v[144:147], v155, s[44:47], s56 offen sc1
    s_waitcnt vmcnt(0)
    s_branch L_HC20
L_HR21:
    s_cmp_eq_u32 s19, 0
    s_cbranch_scc1 L_HC21_OK
    s_sub_u32 s19, s19, 1
    s_sleep 2
    buffer_load_dwordx4 v[148:151], v155, s[44:47], s5 offen sc1
    s_waitcnt vmcnt(0)
    s_branch L_HC21
L_IDLEW:
    s_setprio 0
    s_mov_b32 s59, 0x3f803f80
    v_mov_b32 v40, 0
    v_mov_b32 v41, 0
    v_mov_b32 v42, 0
    v_mov_b32 v43, 0
    v_mov_b32 v44, 0
    v_mov_b32 v45, 0
    v_mov_b32 v46, 0
    v_mov_b32 v47, 0
    s_barrier
    ds_read_b64_tr_b16 v[16:17], v150 offset:0
    ds_read_b64_tr_b16 v[18:19], v150 offset:4096
    ds_read_b64_tr_b16 v[20:21], v151 offset:0
    ds_read_b64_tr_b16 v[22:23], v151 offset:4096
    ds_read_b64_tr_b16 v[24:25], v152 offset:0
    ds_read_b64_tr_b16 v[26:27], v152 offset:4096
    ds_read_b64_tr_b16 v[28:29], v153 offset:0
    ds_read_b64_tr_b16 v[30:31], v153 offset:4096
    s_waitcnt lgkmcnt(4)
    s_nop 0
    v_dot2_f32_bf16 v40, v16, s59, v40
    v_dot2_f32_bf16 v44, v16, v16, v44
    v_dot2_f32_bf16 v41, v20, s59, v41
    v_dot2_f32_bf16 v45, v20, v20, v45
    v_dot2_f32_bf16 v40, v17, s59, v40
    v_dot2_f32_bf16 v44, v17, v17, v44
    v_dot2_f32_bf16 v41, v21, s59, v41
    v_dot2_f32_bf16 v45, v21, v21, v45
    v_dot2_f32_bf16 v40, v18, s59, v40
    v_dot2_f32_bf16 v44, v18, v18, v44
    v_dot2_f32_bf16 v41, v22, s59, v41
    v_dot2_f32_bf16 v45, v22, v22, v45
    v_dot2_f32_bf16 v40, v19, s59, v40
    v_dot2_f32_bf16 v44, v19, v19, v44
    v_dot2_f32_bf16 v41, v23, s59, v41
    v_dot2_f32_bf16 v45, v23, v23, v45
    s_waitcnt lgkmcnt(0)
    s_nop 0
    v_dot2_f32_bf16 v42, v24, s59, v42
    v_dot2_f32_bf16 v46, v24, v24, v46
    v_dot2_f32_bf16 v43, v28, s59, v43
    v_dot2_f32_bf16 v47, v28, v28, v47
    v_dot2_f32_bf16 v42, v25, s59, v42
    v_dot2_f32_bf16 v46, v25, v25, v46
    v_dot2_f32_bf16 v43, v29, s59, v43
    v_dot2_f32_bf16 v47, v29, v29, v47
    v_dot2_f32_bf16 v42, v26, s59, v42
    v_dot2_f32_bf16 v46, v26, v26, v46
    v_dot2_f32_bf16 v43, v30, s59, v43
    v_dot2_f32_bf16 v47, v30, v30, v47
    v_dot2_f32_bf16 v42, v27, s59, v42
    v_dot2_f32_bf16 v46, v27, v27, v46
    v_dot2_f32_bf16 v43, v31, s59, v43
    v_dot2_f32_bf16 v47, v31, v31, v47
    s_barrier
    ds_read_b64_tr_b16 v[16:17], v150 offset:8192
    ds_read_b64_tr_b16 v[18:19], v150 offset:12288
    ds_read_b64_tr_b16 v[20:21], v151 offset:8192
    ds_read_b64_tr_b16 v[22:23], v151 offset:12288
    ds_read_b64_tr_b16 v[24:25], v152 offset:8192
    ds_read_b64_tr_b16 v[26:27], v152 offset:12288
    ds_read_b64_tr_b16 v[28:29], v153 offset:8192
    ds_read_b64_tr_b16 v[30:31], v153 offset:12288
    s_waitcnt lgkmcnt(4)
    v_dot2_f32_bf16 v40, v16, s59, v40
    v_dot2_f32_bf16 v44, v16, v16, v44
    v_dot2_f32_bf16 v41, v20, s59, v41
    v_dot2_f32_bf16 v45, v20, v20, v45
    v_dot2_f32_bf16 v40, v17, s59, v40
    v_dot2_f32_bf16 v44, v17, v17, v44
    v_dot2_f32_bf16 v41, v21, s59, v41
    v_dot2_f32_bf16 v45, v21, v21, v45
    v_dot2_f32_bf16 v40, v18, s59, v40
    v_dot2_f32_bf16 v44, v18, v18, v44
    v_dot2_f32_bf16 v41, v22, s59, v41
    v_dot2_f32_bf16 v45, v22, v22, v45
    v_dot2_f32_bf16 v40, v19, s59, v40
    v_dot2_f32_bf16 v44, v19, v19, v44
    v_dot2_f32_bf16 v41, v23, s59, v41
    v_dot2_f32_bf16 v45, v23, v23, v45
    s_waitcnt lgkmcnt(0)
    s_nop 0
    v_dot2_f32_bf16 v42, v24, s59, v42
    v_dot2_f32_bf16 v46, v24, v24, v46
    v_dot2_f32_bf16 v43, v28, s59, v43
    v_dot2_f32_bf16 v47, v28, v28, v47
    v_dot2_f32_bf16 v42, v25, s59, v42
    v_dot2_f32_bf16 v46, v25, v25, v46
    v_dot2_f32_bf16 v43, v29, s59, v43
    v_dot2_f32_bf16 v47, v29, v29, v47
    v_dot2_f32_bf16 v42, v26, s59, v42
    v_dot2_f32_bf16 v46, v26, v26, v46
    v_dot2_f32_bf16 v43, v30, s59, v43
    v_dot2_f32_bf16 v47, v30, v30, v47
    v_dot2_f32_bf16 v42, v27, s59, v42
    v_dot2_f32_bf16 v46, v27, v27, v46
    v_dot2_f32_bf16 v43, v31, s59, v43
    v_dot2_f32_bf16 v47, v31, v31, v47
    s_barrier
    ds_read_b64_tr_b16 v[16:17], v150 offset:16384
    ds_read_b64_tr_b16 v[18:19], v150 offset:20480
    ds_read_b64_tr_b16 v[20:21], v151 offset:16384
    ds_read_b64_tr_b16 v[22:23], v151 offset:20480
    ds_read_b64_tr_b16 v[24:25], v152 offset:16384
    ds_read_b64_tr_b16 v[26:27], v152 offset:20480
    ds_read_b64_tr_b16 v[28:29], v153 offset:16384
    ds_read_b64_tr_b16 v[30:31], v153 offset:20480
    s_waitcnt lgkmcnt(4)
    v_dot2_f32_bf16 v40, v16, s59, v40
    v_dot2_f32_bf16 v44, v16, v16, v44
    v_dot2_f32_bf16 v41, v20, s59, v41
    v_dot2_f32_bf16 v45, v20, v20, v45
    v_dot2_f32_bf16 v40, v17, s59, v40
    v_dot2_f32_bf16 v44, v17, v17, v44
    v_dot2_f32_bf16 v41, v21, s59, v41
    v_dot2_f32_bf16 v45, v21, v21, v45
    v_dot2_f32_bf16 v40, v18, s59, v40
    v_dot2_f32_bf16 v44, v18, v18, v44
    v_dot2_f32_bf16 v41, v22, s59, v41
    v_dot2_f32_bf16 v45, v22, v22, v45
    v_dot2_f32_bf16 v40, v19, s59, v40
    v_dot2_f32_bf16 v44, v19, v19, v44
    v_dot2_f32_bf16 v41, v23, s59, v41
    v_dot2_f32_bf16 v45, v23, v23, v45
    s_waitcnt lgkmcnt(0)
    s_nop 0
    v_dot2_f32_bf16 v42, v24, s59, v42
    v_dot2_f32_bf16 v46, v24, v24, v46
    v_dot2_f32_bf16 v43, v28, s59, v43
    v_dot2_f32_bf16 v47, v28, v28, v47
    v_dot2_f32_bf16 v42, v25, s59, v42
    v_dot2_f32_bf16 v46, v25, v25, v46
    v_dot2_f32_bf16 v43, v29, s59, v43
    v_dot2_f32_bf16 v47, v29, v29, v47
    v_dot2_f32_bf16 v42, v26, s59, v42
    v_dot2_f32_bf16 v46, v26, v26, v46
    v_dot2_f32_bf16 v43, v30, s59, v43
    v_dot2_f32_bf16 v47, v30, v30, v47
    v_dot2_f32_bf16 v42, v27, s59, v42
    v_dot2_f32_bf16 v46, v27, v27, v46
    v_dot2_f32_bf16 v43, v31, s59, v43
    v_dot2_f32_bf16 v47, v31, v31, v47
    s_barrier
    ds_read_b64_tr_b16 v[16:17], v150 offset:24576
    ds_read_b64_tr_b16 v[18:19], v150 offset:28672
    ds_read_b64_tr_b16 v[20:21], v151 offset:24576
    ds_read_b64_tr_b16 v[22:23], v151 offset:28672
    ds_read_b64_tr_b16 v[24:25], v152 offset:24576
    ds_read_b64_tr_b16 v[26:27], v152 offset:28672
    ds_read_b64_tr_b16 v[28:29], v153 offset:24576
    ds_read_b64_tr_b16 v[30:31], v153 offset:28672
    s_waitcnt lgkmcnt(4)
    v_dot2_f32_bf16 v40, v16, s59, v40
    v_dot2_f32_bf16 v44, v16, v16, v44
    v_dot2_f32_bf16 v41, v20, s59, v41
    v_dot2_f32_bf16 v45, v20, v20, v45
    v_dot2_f32_bf16 v40, v17, s59, v40
    v_dot2_f32_bf16 v44, v17, v17, v44
    v_dot2_f32_bf16 v41, v21, s59, v41
    v_dot2_f32_bf16 v45, v21, v21, v45
    v_dot2_f32_bf16 v40, v18, s59, v40
    v_dot2_f32_bf16 v44, v18, v18, v44
    v_dot2_f32_bf16 v41, v22, s59, v41
    v_dot2_f32_bf16 v45, v22, v22, v45
    v_dot2_f32_bf16 v40, v19, s59, v40
    v_dot2_f32_bf16 v44, v19, v19, v44
    v_dot2_f32_bf16 v41, v23, s59, v41
    v_dot2_f32_bf16 v45, v23, v23, v45
    s_waitcnt lgkmcnt(0)
    s_nop 0
    v_dot2_f32_bf16 v42, v24, s59, v42
    v_dot2_f32_bf16 v46, v24, v24, v46
    v_dot2_f32_bf16 v43, v28, s59, v43
    v_dot2_f32_bf16 v47, v28, v28, v47
    v_dot2_f32_bf16 v42, v25, s59, v42
    v_dot2_f32_bf16 v46, v25, v25, v46
    v_dot2_f32_bf16 v43, v29, s59, v43
    v_dot2_f32_bf16 v47, v29, v29, v47
    v_dot2_f32_bf16 v42, v26, s59, v42
    v_dot2_f32_bf16 v46, v26, v26, v46
    v_dot2_f32_bf16 v43, v30, s59, v43
    v_dot2_f32_bf16 v47, v30, v30, v47
    v_dot2_f32_bf16 v42, v27, s59, v42
    v_dot2_f32_bf16 v46, v27, v27, v46
    v_dot2_f32_bf16 v43, v31, s59, v43
    v_dot2_f32_bf16 v47, v31, v31, v47
    s_barrier
    ds_read_b64_tr_b16 v[16:17], v150 offset:32768
    ds_read_b64_tr_b16 v[18:19], v150 offset:36864
    ds_read_b64_tr_b16 v[20:21], v151 offset:32768
    ds_read_b64_tr_b16 v[22:23], v151 offset:36864
    ds_read_b64_tr_b16 v[24:25], v152 offset:32768
    ds_read_b64_tr_b16 v[26:27], v152 offset:36864
    ds_read_b64_tr_b16 v[28:29], v153 offset:32768
    ds_read_b64_tr_b16 v[30:31], v153 offset:36864
    s_waitcnt lgkmcnt(4)
    v_dot2_f32_bf16 v40, v16, s59, v40
    v_dot2_f32_bf16 v44, v16, v16, v44
    v_dot2_f32_bf16 v41, v20, s59, v41
    v_dot2_f32_bf16 v45, v20, v20, v45
    v_dot2_f32_bf16 v40, v17, s59, v40
    v_dot2_f32_bf16 v44, v17, v17, v44
    v_dot2_f32_bf16 v41, v21, s59, v41
    v_dot2_f32_bf16 v45, v21, v21, v45
    v_dot2_f32_bf16 v40, v18, s59, v40
    v_dot2_f32_bf16 v44, v18, v18, v44
    v_dot2_f32_bf16 v41, v22, s59, v41
    v_dot2_f32_bf16 v45, v22, v22, v45
    v_dot2_f32_bf16 v40, v19, s59, v40
    v_dot2_f32_bf16 v44, v19, v19, v44
    v_dot2_f32_bf16 v41, v23, s59, v41
    v_dot2_f32_bf16 v45, v23, v23, v45
    s_waitcnt lgkmcnt(0)
    s_nop 0
    v_dot2_f32_bf16 v42, v24, s59, v42
    v_dot2_f32_bf16 v46, v24, v24, v46
    v_dot2_f32_bf16 v43, v28, s59, v43
    v_dot2_f32_bf16 v47, v28, v28, v47
    v_dot2_f32_bf16 v42, v25, s59, v42
    v_dot2_f32_bf16 v46, v25, v25, v46
    v_dot2_f32_bf16 v43, v29, s59, v43
    v_dot2_f32_bf16 v47, v29, v29, v47
    v_dot2_f32_bf16 v42, v26, s59, v42
    v_dot2_f32_bf16 v46, v26, v26, v46
    v_dot2_f32_bf16 v43, v30, s59, v43
    v_dot2_f32_bf16 v47, v30, v30, v47
    v_dot2_f32_bf16 v42, v27, s59, v42
    v_dot2_f32_bf16 v46, v27, v27, v46
    v_dot2_f32_bf16 v43, v31, s59, v43
    v_dot2_f32_bf16 v47, v31, v31, v47
    s_barrier
    ds_read_b64_tr_b16 v[16:17], v150 offset:40960
    ds_read_b64_tr_b16 v[18:19], v150 offset:45056
    ds_read_b64_tr_b16 v[20:21], v151 offset:40960
    ds_read_b64_tr_b16 v[22:23], v151 offset:45056
    ds_read_b64_tr_b16 v[24:25], v152 offset:40960
    ds_read_b64_tr_b16 v[26:27], v152 offset:45056
    ds_read_b64_tr_b16 v[28:29], v153 offset:40960
    ds_read_b64_tr_b16 v[30:31], v153 offset:45056
    s_waitcnt lgkmcnt(4)
    v_dot2_f32_bf16 v40, v16, s59, v40
    v_dot2_f32_bf16 v44, v16, v16, v44
    v_dot2_f32_bf16 v41, v20, s59, v41
    v_dot2_f32_bf16 v45, v20, v20, v45
    v_dot2_f32_bf16 v40, v17, s59, v40
    v_dot2_f32_bf16 v44, v17, v17, v44
    v_dot2_f32_bf16 v41, v21, s59, v41
    v_dot2_f32_bf16 v45, v21, v21, v45
    v_dot2_f32_bf16 v40, v18, s59, v40
    v_dot2_f32_bf16 v44, v18, v18, v44
    v_dot2_f32_bf16 v41, v22, s59, v41
    v_dot2_f32_bf16 v45, v22, v22, v45
    v_dot2_f32_bf16 v40, v19, s59, v40
    v_dot2_f32_bf16 v44, v19, v19, v44
    v_dot2_f32_bf16 v41, v23, s59, v41
    v_dot2_f32_bf16 v45, v23, v23, v45
    s_waitcnt lgkmcnt(0)
    s_nop 0
    v_dot2_f32_bf16 v42, v24, s59, v42
    v_dot2_f32_bf16 v46, v24, v24, v46
    v_dot2_f32_bf16 v43, v28, s59, v43
    v_dot2_f32_bf16 v47, v28, v28, v47
    v_dot2_f32_bf16 v42, v25, s59, v42
    v_dot2_f32_bf16 v46, v25, v25, v46
    v_dot2_f32_bf16 v43, v29, s59, v43
    v_dot2_f32_bf16 v47, v29, v29, v47
    v_dot2_f32_bf16 v42, v26, s59, v42
    v_dot2_f32_bf16 v46, v26, v26, v46
    v_dot2_f32_bf16 v43, v30, s59, v43
    v_dot2_f32_bf16 v47, v30, v30, v47
    v_dot2_f32_bf16 v42, v27, s59, v42
    v_dot2_f32_bf16 v46, v27, v27, v46
    v_dot2_f32_bf16 v43, v31, s59, v43
    v_dot2_f32_bf16 v47, v31, v31, v47
    s_barrier
    ds_read_b64_tr_b16 v[16:17], v150 offset:49152
    ds_read_b64_tr_b16 v[18:19], v150 offset:53248
    ds_read_b64_tr_b16 v[20:21], v151 offset:49152
    ds_read_b64_tr_b16 v[22:23], v151 offset:53248
    ds_read_b64_tr_b16 v[24:25], v152 offset:49152
    ds_read_b64_tr_b16 v[26:27], v152 offset:53248
    ds_read_b64_tr_b16 v[28:29], v153 offset:49152
    ds_read_b64_tr_b16 v[30:31], v153 offset:53248
    s_waitcnt lgkmcnt(4)
    v_dot2_f32_bf16 v40, v16, s59, v40
    v_dot2_f32_bf16 v44, v16, v16, v44
    v_dot2_f32_bf16 v41, v20, s59, v41
    v_dot2_f32_bf16 v45, v20, v20, v45
    v_dot2_f32_bf16 v40, v17, s59, v40
    v_dot2_f32_bf16 v44, v17, v17, v44
    v_dot2_f32_bf16 v41, v21, s59, v41
    v_dot2_f32_bf16 v45, v21, v21, v45
    v_dot2_f32_bf16 v40, v18, s59, v40
    v_dot2_f32_bf16 v44, v18, v18, v44
    v_dot2_f32_bf16 v41, v22, s59, v41
    v_dot2_f32_bf16 v45, v22, v22, v45
    v_dot2_f32_bf16 v40, v19, s59, v40
    v_dot2_f32_bf16 v44, v19, v19, v44
    v_dot2_f32_bf16 v41, v23, s59, v41
    v_dot2_f32_bf16 v45, v23, v23, v45
    s_waitcnt lgkmcnt(0)
    s_nop 0
    v_dot2_f32_bf16 v42, v24, s59, v42
    v_dot2_f32_bf16 v46, v24, v24, v46
    v_dot2_f32_bf16 v43, v28, s59, v43
    v_dot2_f32_bf16 v47, v28, v28, v47
    v_dot2_f32_bf16 v42, v25, s59, v42
    v_dot2_f32_bf16 v46, v25, v25, v46
    v_dot2_f32_bf16 v43, v29, s59, v43
    v_dot2_f32_bf16 v47, v29, v29, v47
    v_dot2_f32_bf16 v42, v26, s59, v42
    v_dot2_f32_bf16 v46, v26, v26, v46
    v_dot2_f32_bf16 v43, v30, s59, v43
    v_dot2_f32_bf16 v47, v30, v30, v47
    v_dot2_f32_bf16 v42, v27, s59, v42
    v_dot2_f32_bf16 v46, v27, v27, v46
    v_dot2_f32_bf16 v43, v31, s59, v43
    v_dot2_f32_bf16 v47, v31, v31, v47
    s_barrier
    ds_read_b64_tr_b16 v[16:17], v150 offset:57344
    ds_read_b64_tr_b16 v[18:19], v150 offset:61440
    ds_read_b64_tr_b16 v[20:21], v151 offset:57344
    ds_read_b64_tr_b16 v[22:23], v151 offset:61440
    ds_read_b64_tr_b16 v[24:25], v152 offset:57344
    ds_read_b64_tr_b16 v[26:27], v152 offset:61440
    ds_read_b64_tr_b16 v[28:29], v153 offset:57344
    ds_read_b64_tr_b16 v[30:31], v153 offset:61440
    s_waitcnt lgkmcnt(4)
    v_dot2_f32_bf16 v40, v16, s59, v40
    v_dot2_f32_bf16 v44, v16, v16, v44
    v_dot2_f32_bf16 v41, v20, s59, v41
    v_dot2_f32_bf16 v45, v20, v20, v45
    v_dot2_f32_bf16 v40, v17, s59, v40
    v_dot2_f32_bf16 v44, v17, v17, v44
    v_dot2_f32_bf16 v41, v21, s59, v41
    v_dot2_f32_bf16 v45, v21, v21, v45
    v_dot2_f32_bf16 v40, v18, s59, v40
    v_dot2_f32_bf16 v44, v18, v18, v44
    v_dot2_f32_bf16 v41, v22, s59, v41
    v_dot2_f32_bf16 v45, v22, v22, v45
    v_dot2_f32_bf16 v40, v19, s59, v40
    v_dot2_f32_bf16 v44, v19, v19, v44
    v_dot2_f32_bf16 v41, v23, s59, v41
    v_dot2_f32_bf16 v45, v23, v23, v45
    s_waitcnt lgkmcnt(0)
    s_nop 0
    v_dot2_f32_bf16 v42, v24, s59, v42
    v_dot2_f32_bf16 v46, v24, v24, v46
    v_dot2_f32_bf16 v43, v28, s59, v43
    v_dot2_f32_bf16 v47, v28, v28, v47
    v_dot2_f32_bf16 v42, v25, s59, v42
    v_dot2_f32_bf16 v46, v25, v25, v46
    v_dot2_f32_bf16 v43, v29, s59, v43
    v_dot2_f32_bf16 v47, v29, v29, v47
    v_dot2_f32_bf16 v42, v26, s59, v42
    v_dot2_f32_bf16 v46, v26, v26, v46
    v_dot2_f32_bf16 v43, v30, s59, v43
    v_dot2_f32_bf16 v47, v30, v30, v47
    v_dot2_f32_bf16 v42, v27, s59, v42
    v_dot2_f32_bf16 v46, v27, v27, v46
    v_dot2_f32_bf16 v43, v31, s59, v43
    v_dot2_f32_bf16 v47, v31, v31, v47
    v_permlane16_swap_b32 v40, v41
    s_nop 0
    v_permlane16_swap_b32 v42, v43
    v_permlane16_swap_b32 v44, v45
    v_permlane16_swap_b32 v46, v47
    v_add_f32 v40, v40, v41
    v_add_f32 v42, v42, v43
    v_add_f32 v44, v44, v45
    v_add_f32 v46, v46, v47
    v_permlane32_swap_b32 v40, v42
    s_nop 0
    v_permlane32_swap_b32 v44, v46
    v_add_f32 v96, v40, v42
    v_add_f32 v98, v44, v46
    v_mov_b32 v97, s30
    v_mov_b32 v99, s30
    buffer_store_dwordx4 v[96:99], v6, s[48:51], s58 offen sc1
    s_barrier
    s_barrier
    s_barrier
    s_barrier
    s_barrier
    s_barrier
    s_barrier
    s_barrier
    s_barrier
    s_branch L_EPI_SHORT
L_STATRETRY:
    s_cmp_eq_u32 s19, 0
    s_cbranch_scc1 L_STATOK
    s_sub_u32 s19, s19, 1
    s_sleep 4
    buffer_load_dwordx4 v[96:99], v6, s[48:51], s58 offen sc1
    buffer_load_dwordx4 v[100:103], v15, s[48:51], s58 offen sc1
    s_waitcnt vmcnt(0)
    s_branch L_STATCHK
L_B:
    s_setprio 3
    v_mov_b32 v3, v2
    s_barrier
    s_mov_b32 s48, s28
    s_mov_b32 s49, s29
    s_mov_b32 s50, 0x78000
    s_mov_b32 s51, 0x20000
    s_add_u32 s60, s28, 0x600000
    s_addc_u32 s61, s29, 0
    s_mov_b32 s62, 0x400000
    s_mov_b32 s63, 0x20000
    v_lshlrev_b32_e64 v4, 16, v6
    v_lshl_add_u32 v4, v7, 4, v4
    s_lshl_b32 s36, s38, 19
    s_lshl_b32 s37, s37, 12
    s_add_u32 s36, s36, s37
    s_lshl_b32 s37, s32, 7
    s_add_u32 s36, s36, s37
    s_cmp_lg_u32 s3, 5
    s_cbranch_scc1 L_COLS
    s_mov_b32 s45, 0x3f803f80
    v_mov_b32 v16, 0
    v_mov_b32 v17, 0
    v_lshlrev_b32 v22, 3, v6
    s_lshl_b32 s37, s31, 6
    s_add_u32 s37, s37, 131072
    v_mov_b32 v23, 1
    s_waitcnt lgkmcnt(0)
    s_add_u32 s30, s30, 1
    s_or_b32 s30, s30, 0x7fc00000
    v_mov_b32 v21, s30
    ds_write_b32 v200, v21 offset:12
    s_mov_b64 exec, 1
    ds_add_u32 v200, v23 offset:8
    s_mov_b64 exec, -1
    s_waitcnt vmcnt(9)
    v_dot2_f32_bf16 v16, v128, s45, v16
    v_dot2_f32_bf16 v17, v128, v128, v17
    v_dot2_f32_bf16 v16, v129, s45, v16
    v_dot2_f32_bf16 v17, v129, v129, v17
    v_dot2_f32_bf16 v16, v130, s45, v16
    v_dot2_f32_bf16 v17, v130, v130, v17
    v_dot2_f32_bf16 v16, v131, s45, v16
    v_dot2_f32_bf16 v17, v131, v131, v17
    s_waitcnt vmcnt(8)
    s_nop 0
    v_dot2_f32_bf16 v16, v132, s45, v16
    v_dot2_f32_bf16 v17, v132, v132, v17
    v_dot2_f32_bf16 v16, v133, s45, v16
    v_dot2_f32_bf16 v17, v133, v133, v17
    v_dot2_f32_bf16 v16, v134, s45, v16
    v_dot2_f32_bf16 v17, v134, v134, v17
    v_dot2_f32_bf16 v16, v135, s45, v16
    v_dot2_f32_bf16 v17, v135, v135, v17
    s_waitcnt vmcnt(7)
    s_nop 0
    v_dot2_f32_bf16 v16, v136, s45, v16
    v_dot2_f32_bf16 v17, v136, v136, v17
    v_dot2_f32_bf16 v16, v137, s45, v16
    v_dot2_f32_bf16 v17, v137, v137, v17
    v_dot2_f32_bf16 v16, v138, s45, v16
    v_dot2_f32_bf16 v17, v138, v138, v17
    v_dot2_f32_bf16 v16, v139, s45, v16
    v_dot2_f32_bf16 v17, v139, v139, v17
    s_waitcnt vmcnt(6)
    s_nop 0
    v_dot2_f32_bf16 v16, v140, s45, v16
    v_dot2_f32_bf16 v17, v140, v140, v17
    v_dot2_f32_bf16 v16, v141, s45, v16
    v_dot2_f32_bf16 v17, v141, v141, v17
    v_dot2_f32_bf16 v16, v142, s45, v16
    v_dot2_f32_bf16 v17, v142, v142, v17
    v_dot2_f32_bf16 v16, v143, s45, v16
    v_dot2_f32_bf16 v17, v143, v143, v17
    s_waitcnt vmcnt(5)
    s_nop 0
    v_dot2_f32_bf16 v16, v144, s45, v16
    v_dot2_f32_bf16 v17, v144, v144, v17
    v_dot2_f32_bf16 v16, v145, s45, v16
    v_dot2_f32_bf16 v17, v145, v145, v17
    v_dot2_f32_bf16 v16, v146, s45, v16
    v_dot2_f32_bf16 v17, v146, v146, v17
    v_dot2_f32_bf16 v16, v147, s45, v16
    v_dot2_f32_bf16 v17, v147, v147, v17
    s_waitcnt vmcnt(4)
    s_nop 0
    v_dot2_f32_bf16 v16, v148, s45, v16
    v_dot2_f32_bf16 v17, v148, v148, v17
    v_dot2_f32_bf16 v16, v149, s45, v16
    v_dot2_f32_bf16 v17, v149, v149, v17
    v_dot2_f32_bf16 v16, v150, s45, v16
    v_dot2_f32_bf16 v17, v150, v150, v17
    v_dot2_f32_bf16 v16, v151, s45, v16
    v_dot2_f32_bf16 v17, v151, v151, v17
    s_waitcnt vmcnt(3)
    s_nop 0
    v_dot2_f32_bf16 v16, v152, s45, v16
    v_dot2_f32_bf16 v17, v152, v152, v17
    v_dot2_f32_bf16 v16, v153, s45, v16
    v_dot2_f32_bf16 v17, v153, v153, v17
    v_dot2_f32_bf16 v16, v154, s45, v16
    v_dot2_f32_bf16 v17, v154, v154, v17
    v_dot2_f32_bf16 v16, v155, s45, v16
    v_dot2_f32_bf16 v17, v155, v155, v17
    s_waitcnt vmcnt(2)
    s_nop 0
    v_dot2_f32_bf16 v16, v156, s45, v16
    v_dot2_f32_bf16 v17, v156, v156, v17
    v_dot2_f32_bf16 v16, v157, s45, v16
    v_dot2_f32_bf16 v17, v157, v157, v17
    v_dot2_f32_bf16 v16, v158, s45, v16
    v_dot2_f32_bf16 v17, v158, v158, v17
    v_dot2_f32_bf16 v16, v159, s45, v16
    v_dot2_f32_bf16 v17, v159, v159, v17
    s_nop 1
    v_add_f32_dpp v16, v16, v16 quad_perm:[1,0,3,2] row_mask:0xf bank_mask:0xf
    v_add_f32_dpp v17, v17, v17 quad_perm:[1,0,3,2] row_mask:0xf bank_mask:0xf
    s_nop 0
    v_add_f32_dpp v16, v16, v16 quad_perm:[2,3,0,1] row_mask:0xf bank_mask:0xf
    v_add_f32_dpp v17, v17, v17 quad_perm:[2,3,0,1] row_mask:0xf bank_mask:0xf
    s_nop 0
    v_add_f32_dpp v16, v16, v16 row_half_mirror row_mask:0xf bank_mask:0xf
    v_add_f32_dpp v17, v17, v17 row_half_mirror row_mask:0xf bank_mask:0xf
    v_mul_f32 v16, 0x3b000000, v16
    v_mul_f32 v17, 0x3b000000, v17
    v_fma_f32 v17, -v16, v16, v17
    v_max_f32 v17, 0, v17
    v_cvt_pk_bf16_f32 v18, v16, v17
    v_lshlrev_b32_e64 v20, 16, v18
    v_and_b32 v19, 0xffff0000, v18
    v_add_f32 v19, 0x3727c5ac, v19
    v_cvt_pk_bf16_f32 v19, v19, v19
    v_lshlrev_b32 v19, 16, v19
    v_sqrt_f32 v19, v19
    s_nop 0
    v_cvt_pk_bf16_f32 v19, v19, v19
    v_lshlrev_b32 v19, 16, v19
    v_lshrrev_b32 v20, 16, v20
    v_or_b32 v20, v20, v19
    buffer_store_dwordx2 v[20:21], v22, s[48:51], s37 offen sc1
    s_waitcnt vmcnt(1)
    s_branch L_COLS2
L_COLS:
    s_waitcnt lgkmcnt(0)
    s_add_u32 s30, s30, 1
    s_or_b32 s30, s30, 0x7fc00000
    s_waitcnt vmcnt(0)
L_COLS2:
    v_mov_b32 v109, s30
    v_mov_b32 v111, s30
    v_mov_b32 v113, s30
    v_mov_b32 v115, s30
    v_mov_b32 v117, s30
    v_mov_b32 v119, s30
    v_mov_b32 v121, s30
    v_mov_b32 v123, s30
    v_mov_b32 v108, v100
    v_mov_b32 v110, v104
    buffer_store_dwordx4 v[108:111], v4, s[60:63], s36 offen sc1
    s_add_u32 s36, s36, 16384
    v_mov_b32 v112, v101
    v_mov_b32 v114, v105
    buffer_store_dwordx4 v[112:115], v4, s[60:63], s36 offen sc1
    s_add_u32 s36, s36, 16384
    v_mov_b32 v116, v102
    v_mov_b32 v118, v106
    buffer_store_dwordx4 v[116:119], v4, s[60:63], s36 offen sc1
    s_add_u32 s36, s36, 16384
    v_mov_b32 v120, v103
    v_mov_b32 v122, v107
    buffer_store_dwordx4 v[120:123], v4, s[60:63], s36 offen sc1
    s_add_u32 s36, s36, 16384
    s_setprio 0
    s_cmp_lg_u32 s3, 5
    s_cbranch_scc1 L_NOPF
    s_mul_i32 s13, s2, 5504
    v_min_u32 v10, 42, v1
    v_lshlrev_b32 v10, 7, v10
    v_add_u32 v10, s13, v10
    global_load_dword v102, v10, s[24:25]
L_NOPF:
L_XWAIT:
    ds_read_b64 v[12:13], v200 offset:8
    s_waitcnt lgkmcnt(0)
    v_readfirstlane_b32 s13, v12
    s_nop 0
    s_cmp_lt_u32 s13, 5
    s_cbranch_scc1 L_XWAIT
    s_add_u32 s52, s28, 0x600000
    s_addc_u32 s53, s29, 0
    s_mov_b32 s54, 0x400000
    s_mov_b32 s55, 0x20000
    s_and_b32 s13, s2, 7
    s_lshl_b32 s8, s13, 2
    s_lshr_b32 s18, s32, 3
    s_add_u32 s8, s8, s18
    s_and_b32 s9, s32, 7
    s_and_b32 s6, s13, 6
    s_lshl_b32 s6, s6, 1
    s_and_b32 s18, s32, 3
    s_add_u32 s6, s6, s18
    s_lshl_b32 s10, s13, 1
    s_lshr_b32 s18, s32, 2
    s_and_b32 s13, s13, 1
    s_mul_i32 s7, s13, 7
    s_add_u32 s7, s7, s18
    s_sub_u32 s13, 15, s13
    s_cmp_eq_u32 s18, 7
    s_cselect_b32 s7, s13, s7
    s_and_b32 s11, s3, 3
    v_lshlrev_b32 v15, 4, v3
    v_add_u32 v5, 139264, v15
    s_cmp_eq_u32 s7, 14
    s_cselect_b32 s56, 4, 12
    v_mov_b32 v13, 0x7fff0000
    s_mov_b32 s13, 0x15555556
    s_and_b32 s18, s11, 2
    v_add_u32 v10, 0, v1
    v_mul_hi_u32 v11, v10, s13
    v_mul_u32_u24 v12, 12, v11
    v_sub_u32 v12, v10, v12
    v_bfe_u32 v14, v11, 2, 1
    v_lshlrev_b32 v14, 1, v14
    v_xor_b32 v12, v14, v12
    v_mul_u32_u24 v11, 2752, v11
    v_lshl_add_u32 v204, v12, 4, v11
    v_cmp_le_u32 vcc, s56, v12
    s_nop 1
    v_cndmask_b32 v204, v204, v13, vcc
    v_add_u32 v10, 64, v1
    v_mul_hi_u32 v11, v10, s13
    v_mul_u32_u24 v12, 12, v11
    v_sub_u32 v12, v10, v12
    v_bfe_u32 v14, v11, 2, 1
    v_lshlrev_b32 v14, 1, v14
    v_xor_b32 v12, v14, v12
    v_mul_u32_u24 v11, 2752, v11
    v_lshl_add_u32 v205, v12, 4, v11
    v_cmp_le_u32 vcc, s56, v12
    s_nop 1
    v_cndmask_b32 v205, v205, v13, vcc
    v_add_u32 v10, 128, v1
    v_mul_hi_u32 v11, v10, s13
    v_mul_u32_u24 v12, 12, v11
    v_sub_u32_e64 v12, v10, v12
    v_bfe_u32 v14, v11, 2, 1
    v_lshlrev_b32 v14, 1, v14
    v_xor_b32 v12, v14, v12
    v_mul_u32_u24 v11, 2752, v11
    v_lshl_add_u32 v206, v12, 4, v11
    v_cmp_le_u32 vcc, s56, v12
    s_nop 1
    v_cndmask_b32 v206, v206, v13, vcc
    s_and_b32 s13, s11, 1
    s_mul_i32 s66, s13, 44032
    s_mul_i32 s13, s7, 192
    s_add_u32 s66, s66, s13
    s_mul_i32 s67, s11, 3072
    s_add_u32 s67, s67, 65536
    s_cmp_ge_u32 s11, 2
    s_cselect_b32 s40, s22, s20
    s_cselect_b32 s41, s23, s21
    s_cmp_eq_u32 s7, 15
    s_cselect_b32 s42, 0, 1409024
    s_mov_b32 s43, 0x20000
    s_mov_b32 s19, 65536
    s_lshl_b32 s58, s57, 16
    s_and_b32 s59, s57, 0xffff0000
    s_lshl_b32 s36, s31, 14
    s_add_u32 s37, s36, 4096
    s_add_u32 s38, s36, 8192
    s_add_u32 s39, s36, 12288
    v_and_b32 v10, 3, v1
    v_lshrrev_b32 v11, 2, v1
    s_lshl_b32 s14, s11, 6
    v_add_u32 v11, s14, v11
    v_lshlrev_b32 v180, 6, v11
    v_lshl_add_u32 v180, v10, 4, v180
    v_mul_u32_u24 v181, 4128, v10
    v_lshl_add_u32 v181, v11, 4, v181
    v_add_u32 v181, 139264, v181
    s_mov_b32 s14, 131072
    s_mov_b32 s15, 133120
L_XGATHER:
    buffer_load_dwordx4 v[128:131], v180, s[48:51], s14 offen offset:0 sc1
    buffer_load_dwordx4 v[132:135], v180, s[48:51], s14 offen offset:1024 sc1
    buffer_load_dwordx4 v[136:139], v180, s[48:51], s15 offen offset:0 sc1
    buffer_load_dwordx4 v[140:143], v180, s[48:51], s15 offen offset:1024 sc1
    buffer_load_dwordx4 v[108:111], v15, s[60:63], s36 offen sc1
    buffer_load_dwordx4 v[112:115], v15, s[60:63], s37 offen sc1
    buffer_load_dwordx4 v[116:119], v15, s[60:63], s38 offen sc1
    buffer_load_dwordx4 v[120:123], v15, s[60:63], s39 offen sc1
    s_mov_b64 exec, -1
    v_mov_b32 v10, s30
    v_mov_b32 v11, s30
    s_waitcnt vmcnt(4)
    v_min3_u32 v10, v10, v129, v131
    v_max3_u32 v11, v11, v129, v131
    v_min3_u32 v10, v10, v133, v135
    v_max3_u32 v11, v11, v133, v135
    v_min3_u32 v10, v10, v137, v139
    v_max3_u32 v11, v11, v137, v139
    v_min3_u32 v10, v10, v141, v143
    v_max3_u32 v11, v11, v141, v143
    s_waitcnt vmcnt(0)
    s_nop 0
    v_min3_u32 v10, v10, v109, v111
    v_max3_u32 v11, v11, v109, v111
    v_min3_u32 v10, v10, v113, v115
    v_max3_u32 v11, v11, v113, v115
    v_min3_u32 v10, v10, v117, v119
    v_max3_u32 v11, v11, v117, v119
    v_min3_u32 v10, v10, v121, v123
    v_max3_u32 v11, v11, v121, v123
    v_cmp_ne_u32 vcc, v10, v11
    s_nop 0
    s_cmp_eq_u64 vcc, 0
    s_cbranch_scc1 L_XOK
    s_cmp_eq_u32 s19, 0
    s_cbranch_scc1 L_XOK
    s_sub_u32 s19, s19, 1
    s_sleep 4
    s_mov_b64 exec, vcc
    s_branch L_XGATHER
L_XOK:
    v_and_b32 v129, 0xffff0000, v128
    v_lshlrev_b32 v128, 16, v128
    v_rcp_f32 v129, v129
    v_and_b32 v131, 0xffff0000, v130
    v_lshlrev_b32 v130, 16, v130
    v_rcp_f32 v131, v131
    s_nop 0
    ds_write_b128 v181, v[128:131] offset:0
    v_and_b32 v133, 0xffff0000, v132
    v_lshlrev_b32 v132, 16, v132
    v_rcp_f32_e64 v133, v133
    v_and_b32 v135, 0xffff0000, v134
    v_lshlrev_b32 v134, 16, v134
    v_rcp_f32 v135, v135
    s_nop 0
    ds_write_b128 v181, v[132:135] offset:256
    v_and_b32 v137, 0xffff0000, v136
    v_lshlrev_b32 v136, 16, v136
    v_rcp_f32_e64 v137, v137
    v_and_b32 v139, 0xffff0000, v138
    v_lshlrev_b32 v138, 16, v138
    v_rcp_f32 v139, v139
    s_nop 0
    ds_write_b128 v181, v[136:139] offset:512
    v_and_b32 v141, 0xffff0000, v140
    v_lshlrev_b32 v140, 16, v140
    v_rcp_f32_e64 v141, v141
    v_and_b32 v143, 0xffff0000, v142
    v_lshlrev_b32 v142, 16, v142
    v_rcp_f32 v143, v143
    s_nop 0
    ds_write_b128 v181, v[140:143] offset:768
    v_lshlrev_b32 v40, 16, v108
    v_and_b32 v41, 0xffff0000, v108
    v_lshlrev_b32_e64 v42, 16, v110
    v_and_b32 v43, 0xffff0000, v110
    v_lshlrev_b32_e64 v44, 16, v112
    v_and_b32 v45, 0xffff0000, v112
    v_lshlrev_b32_e64 v46, 16, v114
    v_and_b32 v47, 0xffff0000, v114
    v_lshlrev_b32_e64 v48, 16, v116
    v_and_b32 v49, 0xffff0000, v116
    v_lshlrev_b32_e64 v50, 16, v118
    v_and_b32 v51, 0xffff0000, v118
    v_lshlrev_b32_e64 v52, 16, v120
    v_and_b32 v53, 0xffff0000, v120
    v_lshlrev_b32_e64 v54, 16, v122
    v_and_b32 v55, 0xffff0000, v122
    ds_read_b128 v[24:27], v5 offset:0
    ds_read_b128 v[28:31], v5 offset:4128
    ds_read_b128 v[32:35], v5 offset:8256
    ds_read_b128 v[36:39], v5 offset:12384
    s_waitcnt lgkmcnt(3)
    v_pk_add_f32 v[80:81], v[40:41], v[24:25] op_sel:[0,0] op_sel_hi:[1,0] neg_lo:[0,1] neg_hi:[0,1]
    v_pk_add_f32 v[82:83], v[42:43], v[26:27] op_sel:[0,0] op_sel_hi:[1,0] neg_lo:[0,1] neg_hi:[0,1]
    s_waitcnt lgkmcnt(2)
    v_pk_add_f32 v[84:85], v[44:45], v[28:29] op_sel:[0,0] op_sel_hi:[1,0] neg_lo:[0,1] neg_hi:[0,1]
    v_pk_add_f32 v[86:87], v[46:47], v[30:31] op_sel:[0,0] op_sel_hi:[1,0] neg_lo:[0,1] neg_hi:[0,1]
    s_waitcnt lgkmcnt(1)
    v_pk_add_f32 v[88:89], v[48:49], v[32:33] op_sel:[0,0] op_sel_hi:[1,0] neg_lo:[0,1] neg_hi:[0,1]
    v_pk_add_f32 v[90:91], v[50:51], v[34:35] op_sel:[0,0] op_sel_hi:[1,0] neg_lo:[0,1] neg_hi:[0,1]
    s_waitcnt lgkmcnt(0)
    v_pk_add_f32 v[92:93], v[52:53], v[36:37] op_sel:[0,0] op_sel_hi:[1,0] neg_lo:[0,1] neg_hi:[0,1]
    v_pk_add_f32 v[94:95], v[54:55], v[38:39] op_sel:[0,0] op_sel_hi:[1,0] neg_lo:[0,1] neg_hi:[0,1]
    v_cvt_pk_bf16_f32 v80, v80, v81
    v_cvt_pk_bf16_f32 v82, v82, v83
    v_cvt_pk_bf16_f32 v84, v84, v85
    v_cvt_pk_bf16_f32 v86, v86, v87
    v_cvt_pk_bf16_f32 v88, v88, v89
    v_cvt_pk_bf16_f32 v90, v90, v91
    v_cvt_pk_bf16_f32 v92, v92, v93
    v_cvt_pk_bf16_f32 v94, v94, v95
    v_and_b32 v81, 0xffff0000, v80
    v_lshlrev_b32_e64 v80, 16, v80
    v_and_b32 v83, 0xffff0000, v82
    v_lshlrev_b32_e64 v82, 16, v82
    v_and_b32 v85, 0xffff0000, v84
    v_lshlrev_b32_e64 v84, 16, v84
    v_and_b32 v87, 0xffff0000, v86
    v_lshlrev_b32_e64 v86, 16, v86
    v_and_b32 v89, 0xffff0000, v88
    v_lshlrev_b32_e64 v88, 16, v88
    v_and_b32 v91, 0xffff0000, v90
    v_lshlrev_b32_e64 v90, 16, v90
    v_and_b32 v93, 0xffff0000, v92
    v_lshlrev_b32_e64 v92, 16, v92
    v_and_b32 v95, 0xffff0000, v94
    v_lshlrev_b32_e64 v94, 16, v94
    v_pk_mul_f32 v[80:81], v[80:81], v[24:25] op_sel:[0,1] op_sel_hi:[1,1]
    v_pk_mul_f32 v[82:83], v[82:83], v[26:27] op_sel:[0,1] op_sel_hi:[1,1]
    v_pk_mul_f32 v[84:85], v[84:85], v[28:29] op_sel:[0,1] op_sel_hi:[1,1]
    v_pk_mul_f32 v[86:87], v[86:87], v[30:31] op_sel:[0,1] op_sel_hi:[1,1]
    v_pk_mul_f32 v[88:89], v[88:89], v[32:33] op_sel:[0,1] op_sel_hi:[1,1]
    v_pk_mul_f32 v[90:91], v[90:91], v[34:35] op_sel:[0,1] op_sel_hi:[1,1]
    v_pk_mul_f32 v[92:93], v[92:93], v[36:37] op_sel:[0,1] op_sel_hi:[1,1]
    v_pk_mul_f32 v[94:95], v[94:95], v[38:39] op_sel:[0,1] op_sel_hi:[1,1]
    v_cvt_pk_bf16_f32 v72, v80, v82
    v_cvt_pk_bf16_f32 v73, v84, v86
    v_cvt_pk_bf16_f32 v74, v88, v90
    v_cvt_pk_bf16_f32 v75, v92, v94
    ds_write_b128 v15, v[72:75] offset:49920
    v_cvt_pk_bf16_f32 v76, v81, v83
    v_cvt_pk_bf16_f32 v77, v85, v87
    v_cvt_pk_bf16_f32 v78, v89, v91
    v_cvt_pk_bf16_f32 v79, v93, v95
    ds_write_b128 v15, v[76:79] offset:54528
    s_waitcnt lgkmcnt(0)
    s_barrier
    s_cmp_lg_u32 s3, 7
    s_cbranch_scc1 L_NOF1
    v_mov_b32 v10, s30
    s_add_u32 s13, s33, 163840
    buffer_store_dword v10, v8, s[48:51], s13 offen sc1
L_NOF1:
    s_add_u32 s13, s10, 0
    s_and_b32 s13, s13, 15
    s_mul_i32 s13, s13, 88064
    s_add_u32 s13, s13, s66
    s_add_u32 m0, s67, 0
    s_nop 0
    buffer_load_dwordx4 v204, s[40:43], s13 offen lds
    s_add_u32 m0, s67, 1024
    s_nop 0
    buffer_load_dwordx4 v205, s[40:43], s13 offen lds
    s_add_u32 m0, s67, 2048
    s_nop 0
    buffer_load_dwordx4 v206, s[40:43], s13 offen lds
    s_add_u32 s13, s10, 1
    s_and_b32 s13, s13, 15
    s_mul_i32 s13, s13, 88064
    s_add_u32 s13, s13, s66
    s_add_u32 m0, s67, 12288
    s_nop 0
    buffer_load_dwordx4 v204, s[40:43], s13 offen lds
    s_add_u32 m0, s67, 13312
    s_nop 0
    buffer_load_dwordx4 v205, s[40:43], s13 offen lds
    s_add_u32 m0, s67, 14336
    s_nop 0
    buffer_load_dwordx4 v206, s[40:43], s13 offen lds
    s_add_u32 s13, s10, 2
    s_and_b32 s13, s13, 15
    s_mul_i32 s13, s13, 88064
    s_add_u32 s13, s13, s66
    s_add_u32 m0, s67, 24576
    s_nop 0
    buffer_load_dwordx4 v204, s[40:43], s13 offen lds
    s_add_u32 m0, s67, 25600
    s_nop 0
    buffer_load_dwordx4 v205, s[40:43], s13 offen lds
    s_add_u32 m0, s67, 26624
    s_nop 0
    buffer_load_dwordx4 v206, s[40:43], s13 offen lds
    s_add_u32 s13, s10, 3
    s_and_b32 s13, s13, 15
    s_mul_i32 s13, s13, 88064
    s_add_u32 s13, s13, s66
    s_add_u32 m0, s67, 36864
    s_nop 0
    buffer_load_dwordx4 v204, s[40:43], s13 offen lds
    s_add_u32 m0, s67, 37888
    s_nop 0
    buffer_load_dwordx4 v205, s[40:43], s13 offen lds
    s_add_u32 m0, s67, 38912
    s_nop 0
    buffer_load_dwordx4 v206, s[40:43], s13 offen lds
    v_lshlrev_b32_e64 v56, 16, v72
    v_and_b32 v57, 0xffff0000, v72
    v_mul_f32 v56, s58, v56
    v_mul_f32 v57, s58, v57
    v_cvt_pk_bf16_f32 v56, v56, v57
    v_and_b32 v57, 0xffff0000, v56
    v_lshlrev_b32 v56, 16, v56
    v_lshlrev_b32 v58, 16, v73
    v_and_b32 v59, 0xffff0000, v73
    v_mul_f32 v58, s58, v58
    v_mul_f32 v59, s58, v59
    v_cvt_pk_bf16_f32 v58, v58, v59
    v_and_b32 v59, 0xffff0000, v58
    v_lshlrev_b32 v58, 16, v58
    v_lshlrev_b32 v60, 16, v74
    v_and_b32 v61, 0xffff0000, v74
    v_mul_f32 v60, s58, v60
    v_mul_f32 v61, s58, v61
    v_cvt_pk_bf16_f32 v60, v60, v61
    v_and_b32 v61, 0xffff0000, v60
    v_lshlrev_b32 v60, 16, v60
    v_lshlrev_b32 v62, 16, v75
    v_and_b32 v63, 0xffff0000, v75
    v_mul_f32 v62, s58, v62
    v_mul_f32 v63, s58, v63
    v_cvt_pk_bf16_f32 v62, v62, v63
    v_and_b32 v63, 0xffff0000, v62
    v_lshlrev_b32 v62, 16, v62
    v_lshlrev_b32 v64, 16, v76
    v_and_b32 v65, 0xffff0000, v76
    v_mul_f32 v64, s59, v64
    v_mul_f32 v65, s59, v65
    v_cvt_pk_bf16_f32 v64, v64, v65
    v_and_b32 v65, 0xffff0000, v64
    v_lshlrev_b32 v64, 16, v64
    v_lshlrev_b32 v66, 16, v77
    v_and_b32 v67, 0xffff0000, v77
    v_mul_f32 v66, s59, v66
    v_mul_f32 v67, s59, v67
    v_cvt_pk_bf16_f32 v66, v66, v67
    v_and_b32 v67, 0xffff0000, v66
    v_lshlrev_b32 v66, 16, v66
    v_lshlrev_b32 v68, 16, v78
    v_and_b32 v69, 0xffff0000, v78
    v_mul_f32 v68, s59, v68
    v_mul_f32 v69, s59, v69
    v_cvt_pk_bf16_f32 v68, v68, v69
    v_and_b32 v69, 0xffff0000, v68
    v_lshlrev_b32 v68, 16, v68
    v_lshlrev_b32 v70, 16, v79
    v_and_b32 v71, 0xffff0000, v79
    v_mul_f32 v70, s59, v70
    v_mul_f32 v71, s59, v71
    v_cvt_pk_bf16_f32 v70, v70, v71
    v_and_b32 v71, 0xffff0000, v70
    v_lshlrev_b32 v70, 16, v70
    v_mov_b32 v80, v40
    v_mov_b32 v81, v42
    v_mov_b32 v82, v44
    v_mov_b32 v83, v46
    v_mov_b32 v84, v48
    v_mov_b32 v85, v50
    v_mov_b32 v86, v52
    v_mov_b32 v87, v54
    v_mov_b32 v88, v41
    v_mov_b32 v89, v43
    v_mov_b32 v90, v45
    v_mov_b32 v91, v47
    v_mov_b32 v92, v49
    v_mov_b32 v93, v51
    v_mov_b32 v94, v53
    v_mov_b32 v95, v55
    v_and_b32 v14, 1, v3
    v_bfe_u32 v13, v3, 1, 4
    v_lshlrev_b32 v12, 3, v14
    v_xor_b32 v13, v13, v12
    v_lshlrev_b32_e64 v13, 4, v13
    v_lshl_add_u32 v13, v14, 9, v13
    v_lshrrev_b32_e64 v14, 5, v3
    v_lshl_add_u32 v13, v14, 10, v13
    v_lshrrev_b32 v14, 4, v3
    v_add_u32 v14, s31, v14
    v_and_b32 v14, 15, v14
    v_lshlrev_b32 v14, 9, v14
    v_and_b32_e64 v15, 15, v3
    v_lshl_add_u32 v14, v15, 4, v14
    s_lshl_b32 s62, s31, 14
    v_lshlrev_b32 v10, 4, v1
    s_mov_b32 s14, 163840
    s_cmp_lg_u32 s3, 4
    s_cbranch_scc1 L_NOF1L
    s_waitcnt vmcnt(3)
    buffer_load_dwordx4 v[96:99], v10, s[48:51], s14 offen sc1
L_NOF1L:
    s_setprio 3
    s_waitcnt vmcnt(0)
    s_barrier
    ds_read_b128 v[100:103], v13 offset:0
    ds_read_b128 v[104:107], v13 offset:256
    ds_read_b128 v[108:111], v13 offset:8192
    ds_read_b128 v[112:115], v13 offset:8448
    ds_read_b128 v[116:119], v13 offset:16384
    ds_read_b128 v[120:123], v13 offset:16640
    ds_read_b128 v[124:127], v13 offset:24576
    ds_read_b128 v[128:131], v13 offset:24832
    s_waitcnt lgkmcnt(4)
    s_nop 0
    v_pk_add_f32 v[100:101], v[100:101], v[108:109]
    v_pk_add_f32 v[102:103], v[102:103], v[110:111]
    v_pk_add_f32 v[104:105], v[104:105], v[112:113]
    v_pk_add_f32 v[106:107], v[106:107], v[114:115]
    v_cvt_pk_bf16_f32 v100, v100, v101
    v_cvt_pk_bf16_f32 v102, v102, v103
    v_cvt_pk_bf16_f32 v104, v104, v105
    v_cvt_pk_bf16_f32 v106, v106, v107
    v_and_b32 v101, 0xffff0000, v100
    v_lshlrev_b32_e64 v100, 16, v100
    v_and_b32 v103, 0xffff0000, v102
    v_lshlrev_b32_e64 v102, 16, v102
    v_and_b32 v105, 0xffff0000, v104
    v_lshlrev_b32_e64 v104, 16, v104
    v_and_b32 v107, 0xffff0000, v106
    v_lshlrev_b32_e64 v106, 16, v106
    v_pk_add_f32 v[100:101], v[100:101], v[56:57]
    v_pk_add_f32 v[102:103], v[102:103], v[58:59]
    v_pk_add_f32 v[104:105], v[104:105], v[60:61]
    v_pk_add_f32 v[106:107], v[106:107], v[62:63]
    v_cvt_pk_bf16_f32 v100, v100, v101
    v_cvt_pk_bf16_f32 v102, v102, v103
    v_cvt_pk_bf16_f32 v104, v104, v105
    v_cvt_pk_bf16_f32 v106, v106, v107
    v_and_b32 v101, 0xffff0000, v100
    v_lshlrev_b32_e64 v100, 16, v100
    v_and_b32 v103, 0xffff0000, v102
    v_lshlrev_b32_e64 v102, 16, v102
    v_and_b32 v105, 0xffff0000, v104
    v_lshlrev_b32_e64 v104, 16, v104
    v_and_b32 v107, 0xffff0000, v106
    v_lshlrev_b32_e64 v106, 16, v106
    v_pk_add_f32 v[100:101], v[100:101], v[80:81]
    v_pk_add_f32 v[102:103], v[102:103], v[82:83]
    v_pk_add_f32 v[104:105], v[104:105], v[84:85]
    v_pk_add_f32 v[106:107], v[106:107], v[86:87]
    v_cvt_pk_bf16_f32 v108, v100, v101
    v_cvt_pk_bf16_f32 v109, v102, v103
    v_cvt_pk_bf16_f32 v110, v104, v105
    v_cvt_pk_bf16_f32 v111, v106, v107
    buffer_store_dwordx4 v[108:111], v14, s[52:55], s62 offen offset:0 sc1
    s_waitcnt lgkmcnt(0)
    s_nop 0
    v_pk_add_f32 v[116:117], v[116:117], v[124:125]
    v_pk_add_f32 v[118:119], v[118:119], v[126:127]
    v_pk_add_f32 v[120:121], v[120:121], v[128:129]
    v_pk_add_f32 v[122:123], v[122:123], v[130:131]
    v_cvt_pk_bf16_f32 v116, v116, v117
    v_cvt_pk_bf16_f32 v118, v118, v119
    v_cvt_pk_bf16_f32 v120, v120, v121
    v_cvt_pk_bf16_f32 v122, v122, v123
    v_and_b32 v117, 0xffff0000, v116
    v_lshlrev_b32_e64 v116, 16, v116
    v_and_b32 v119, 0xffff0000, v118
    v_lshlrev_b32_e64 v118, 16, v118
    v_and_b32 v121, 0xffff0000, v120
    v_lshlrev_b32_e64 v120, 16, v120
    v_and_b32 v123, 0xffff0000, v122
    v_lshlrev_b32_e64 v122, 16, v122
    v_pk_add_f32 v[116:117], v[116:117], v[64:65]
    v_pk_add_f32 v[118:119], v[118:119], v[66:67]
    v_pk_add_f32 v[120:121], v[120:121], v[68:69]
    v_pk_add_f32 v[122:123], v[122:123], v[70:71]
    v_cvt_pk_bf16_f32 v116, v116, v117
    v_cvt_pk_bf16_f32 v118, v118, v119
    v_cvt_pk_bf16_f32 v120, v120, v121
    v_cvt_pk_bf16_f32 v122, v122, v123
    v_and_b32 v117, 0xffff0000, v116
    v_lshlrev_b32_e64 v116, 16, v116
    v_and_b32 v119, 0xffff0000, v118
    v_lshlrev_b32_e64 v118, 16, v118
    v_and_b32 v121, 0xffff0000, v120
    v_lshlrev_b32_e64 v120, 16, v120
    v_and_b32 v123, 0xffff0000, v122
    v_lshlrev_b32_e64 v122, 16, v122
    v_pk_add_f32 v[116:117], v[116:117], v[88:89]
    v_pk_add_f32 v[118:119], v[118:119], v[90:91]
    v_pk_add_f32 v[120:121], v[120:121], v[92:93]
    v_pk_add_f32 v[122:123], v[122:123], v[94:95]
    v_cvt_pk_bf16_f32 v124, v116, v117
    v_cvt_pk_bf16_f32 v125, v118, v119
    v_cvt_pk_bf16_f32 v126, v120, v121
    v_cvt_pk_bf16_f32 v127, v122, v123
    buffer_store_dwordx4 v[124:127], v14, s[52:55], s62 offen offset:256 sc1
    s_cmp_lg_u32 s3, 4
    s_cbranch_scc1 L_F1OK
L_F1:
    v_min3_u32 v11, v96, v97, v98
    v_max3_u32 v12, v96, v97, v98
    v_min3_u32 v11, v11, v99, s30
    v_max3_u32 v12, v12, v99, s30
    v_cmp_ne_u32 vcc, v11, v12
    s_cbranch_vccz L_F1OK
    s_cmp_eq_u32 s19, 0
    s_cbranch_scc1 L_F1OK
    s_sub_u32 s19, s19, 1
    s_sleep 4
    buffer_load_dwordx4 v[96:99], v10, s[48:51], s14 offen sc1
    s_waitcnt vmcnt(0)
    s_branch L_F1
L_F1OK:
    s_barrier
    s_add_u32 s13, s10, 4
    s_and_b32 s13, s13, 15
    s_mul_i32 s13, s13, 88064
    s_add_u32 s13, s13, s66
    s_add_u32 m0, s67, 49152
    s_nop 0
    buffer_load_dwordx4 v204, s[40:43], s13 offen lds
    s_add_u32 m0, s67, 50176
    s_nop 0
    buffer_load_dwordx4 v205, s[40:43], s13 offen lds
    s_add_u32 m0, s67, 51200
    s_nop 0
    buffer_load_dwordx4 v206, s[40:43], s13 offen lds
    s_add_u32 s13, s10, 5
    s_and_b32 s13, s13, 15
    s_mul_i32 s13, s13, 88064
    s_add_u32 s13, s13, s66
    s_add_u32 m0, s67, 61440
    s_nop 0
    buffer_load_dwordx4 v204, s[40:43], s13 offen lds
    s_add_u32 m0, s67, 62464
    s_nop 0
    buffer_load_dwordx4 v205, s[40:43], s13 offen lds
    s_add_u32 m0, s67, 63488
    s_nop 0
    buffer_load_dwordx4 v206, s[40:43], s13 offen lds
    s_add_u32 s13, s10, 6
    s_and_b32 s13, s13, 15
    s_mul_i32 s13, s13, 88064
    s_add_u32 s13, s13, s66
    s_add_u32 m0, s67, 73728
    s_nop 0
    buffer_load_dwordx4 v204, s[40:43], s13 offen lds
    s_add_u32 m0, s67, 74752
    s_nop 0
    buffer_load_dwordx4 v205, s[40:43], s13 offen lds
    s_add_u32 m0, s67, 75776
    s_nop 0
    buffer_load_dwordx4 v206, s[40:43], s13 offen lds
    s_add_u32 s13, s10, 7
    s_and_b32 s13, s13, 15
    s_mul_i32 s13, s13, 88064
    s_add_u32 s13, s13, s66
    s_add_u32 m0, s67, 86016
    s_nop 0
    buffer_load_dwordx4 v204, s[40:43], s13 offen lds
    s_add_u32 m0, s67, 87040
    s_nop 0
    buffer_load_dwordx4 v205, s[40:43], s13 offen lds
    s_add_u32 m0, s67, 88064
    s_nop 0
    buffer_load_dwordx4 v206, s[40:43], s13 offen lds
    s_mov_b32 s56, s67
    v_bfe_u32 v2, v1, 4, 1
    v_lshrrev_b32_e64 v3, 5, v1
    v_bfe_u32 v4, v1, 2, 2
    v_and_b32 v5, 3, v1
    v_lshlrev_b32 v6, 4, v1
    v_and_b32 v7, 0x30, v1
    v_lshlrev_b32 v7, 2, v7
    v_xor_b32_e64 v7, v7, v6
    v_and_b32 v7, 0x1ff, v7
    v_lshrrev_b32 v8, 3, v1
    v_lshlrev_b32 v9, 2, v2
    v_and_b32 v14, 7, v1
    v_xor_b32 v9, v9, v14
    v_lshlrev_b32_e64 v9, 4, v9
    v_lshl_add_u32 v13, v8, 10, v9
    s_lshl_b32 s64, s9, 7
    v_add_u32 v13, s64, v13
    s_lshl_b32 s64, s9, 5
    s_lshl_b32 s67, s11, 3
    s_add_u32 s64, s64, s67
    s_and_b32 s67, s3, 4
    s_add_u32 s64, s64, s67
    v_lshrrev_b32 v9, 4, v1
    v_add_u32 v9, s64, v9
    v_and_b32 v8, 1, v8
    v_lshlrev_b32_e64 v8, 8, v8
    v_lshl_add_u32 v8, v14, 4, v8
    v_lshl_add_u32 v8, v9, 14, v8
    s_lshr_b32 s64, s8, 1
    v_add_u32 v9, s64, v9
    v_and_b32_e64 v9, 15, v9
    v_lshl_add_u32 v9, v9, 9, v8
    s_and_b32 s67, s8, 1
    s_lshl_b32 s67, s67, 7
    v_add_u32 v9, s67, v9
    s_mov_b32 s36, s24
    s_mov_b32 s37, s25
    s_mov_b32 s38, 0x158000
    s_mov_b32 s39, 0x20000
    s_add_u32 s44, s28, 0x78000
    s_addc_u32 s45, s29, 0
    s_mov_b32 s46, 0x988000
    s_mov_b32 s47, 0x20000
    s_mov_b32 s67, s56
    s_lshl_b32 s64, s11, 11
    s_lshl_b32 s65, s11, 2
    v_and_b32 v86, 0x30, v1
    v_lshlrev_b32 v86, 1, v86
    v_xor_b32 v86, v86, v6
    v_and_b32 v86, 0x1ff, v86
    v_add_u32 v84, s65, v3
    v_add_u32 v14, s6, v84
    v_and_b32_e64 v14, 15, v14
    v_lshl_add_u32 v14, v14, 9, v86
    v_lshl_add_u32 v84, v84, 14, v14
    s_add_u32 s65, s65, 2
    v_xor_b32 v86, 128, v86
    v_add_u32 v85, s65, v3
    v_add_u32 v14, s6, v85
    v_and_b32 v14, 15, v14
    v_lshl_add_u32 v14, v14, 9, v86
    v_lshl_add_u32 v85, v85, 14, v14
    v_add_u32 v89, s64, v6
    s_setprio 3
    s_mul_i32 s60, s11, 344064
    v_and_b32 v94, 7, v1
    v_lshlrev_b32 v94, 7, v94
    s_lshl_b32 s61, s7, 10
    s_add_u32 s61, s61, 458752
    v_min_u32 v93, 42, v1
    v_lshlrev_b32 v93, 7, v93
    s_mul_i32 s62, s2, 5504
    s_lshl_b32 s63, s6, 2
    s_add_u32 s63, s63, s11
    s_mul_i32 s63, s63, 58
    s_lshl_b32 s13, s7, 2
    s_add_u32 s63, s63, s13
    s_lshl_b32 s63, s63, 10
    s_cmp_eq_u32 s7, 14
    s_cselect_b32 s59, 0x7fff0000, s63
    v_mov_b32 v72, s30
    v_mov_b32 v73, s30
    v_mov_b32 v74, s30
    v_mov_b32 v75, s30
    s_lshl_b32 s57, s6, 4
    s_add_u32 s57, s57, s7
    s_lshl_b32 s57, s57, 2
    s_add_u32 s57, s57, 165888
    s_lshr_b32 s58, s8, 1
    s_lshl_b32 s58, s58, 6
    s_add_u32 s58, s58, 165888
    v_min_u32 v71, 14, v1
    v_lshlrev_b32 v71, 2, v71
    v_mov_b32 v70, 0
    s_waitcnt vmcnt(12)
    s_cmp_eq_u32 s7, 15
    s_cbranch_scc1 L_STATS_H
    s_add_u32 s13, s10, 0
    s_and_b32 s13, s13, 15
    s_lshl_b32 s13, s13, 18
    s_add_u32 m0, s64, 0
    s_nop 0
    buffer_load_dwordx4 v84, s[52:55], s13 offen sc1 lds
    s_add_u32 m0, s64, 1024
    s_nop 0
    buffer_load_dwordx4 v85, s[52:55], s13 offen sc1 lds
    s_add_u32 s13, s10, 1
    s_and_b32 s13, s13, 15
    s_lshl_b32 s13, s13, 18
    s_add_u32 m0, s64, 8192
    s_nop 0
    buffer_load_dwordx4 v84, s[52:55], s13 offen sc1 lds
    s_add_u32 m0, s64, 9216
    s_nop 0
    buffer_load_dwordx4 v85, s[52:55], s13 offen sc1 lds
    s_add_u32 s13, s10, 2
    s_and_b32 s13, s13, 15
    s_lshl_b32 s13, s13, 18
    s_add_u32 m0, s64, 16384
    s_nop 0
    buffer_load_dwordx4 v84, s[52:55], s13 offen sc1 lds
    s_add_u32 m0, s64, 17408
    s_nop 0
    buffer_load_dwordx4 v85, s[52:55], s13 offen sc1 lds
    s_add_u32 s13, s10, 3
    s_and_b32 s13, s13, 15
    s_lshl_b32 s13, s13, 18
    s_add_u32 m0, s64, 24576
    s_nop 0
    buffer_load_dwordx4 v84, s[52:55], s13 offen sc1 lds
    s_add_u32 m0, s64, 25600
    s_nop 0
    buffer_load_dwordx4 v85, s[52:55], s13 offen sc1 lds
    buffer_store_dwordx4 v[72:75], v6, s[44:47], s63 offen offset:0 sc1
    buffer_store_dwordx4 v[72:75], v6, s[44:47], s63 offen offset:1024 sc1
    buffer_store_dwordx4 v[72:75], v6, s[44:47], s59 offen offset:2048 sc1
    buffer_store_dwordx4 v[72:75], v6, s[44:47], s59 offen offset:3072 sc1
    s_waitcnt vmcnt(10)
    ds_read_b128 v[76:79], v89 offset:0
    ds_read_b128 v[80:83], v89 offset:1024
L_XC0:
    s_waitcnt lgkmcnt(0)
    v_xor_b32 v76, s30, v77
    v_xor_b32 v78, s30, v79
    v_min_u32 v76, v76, v78
    v_xor_b32 v80, s30, v81
    v_xor_b32 v82, s30, v83
    v_min_u32 v80, v80, v82
    v_min_u32 v76, v76, v80
    v_cmp_eq_u32 vcc, 0, v76
    s_cbranch_vccz L_XC0_OK
    s_cmp_eq_u32 s19, 0
    s_cbranch_scc1 L_XC0_OK
    s_sub_u32 s19, s19, 1
    s_sleep 2
    s_add_u32 s13, s10, 0
    s_and_b32 s13, s13, 15
    s_lshl_b32 s13, s13, 18
    s_add_u32 m0, s64, 0
    s_nop 0
    buffer_load_dwordx4 v84, s[52:55], s13 offen sc1 lds
    s_add_u32 m0, s64, 1024
    s_nop 0
    buffer_load_dwordx4 v85, s[52:55], s13 offen sc1 lds
    s_waitcnt vmcnt(0)
    ds_read_b128 v[76:79], v89 offset:0
    ds_read_b128 v[80:83], v89 offset:1024
    s_branch L_XC0
L_XC0_OK:
    s_barrier
    s_waitcnt vmcnt(8)
    ds_read_b128 v[76:79], v89 offset:8192
    ds_read_b128 v[80:83], v89 offset:9216
    s_add_u32 s13, s10, 4
    s_and_b32 s13, s13, 15
    s_lshl_b32 s13, s13, 18
    s_add_u32 m0, s64, 32768
    s_nop 0
    buffer_load_dwordx4 v84, s[52:55], s13 offen sc1 lds
    s_add_u32 m0, s64, 33792
    s_nop 0
    buffer_load_dwordx4 v85, s[52:55], s13 offen sc1 lds
    s_add_u32 s13, s10, 5
    s_and_b32 s13, s13, 15
    s_lshl_b32 s13, s13, 18
    s_add_u32 m0, s64, 40960
    s_nop 0
    buffer_load_dwordx4 v84, s[52:55], s13 offen sc1 lds
    s_add_u32 m0, s64, 41984
    s_nop 0
    buffer_load_dwordx4 v85, s[52:55], s13 offen sc1 lds
    s_waitcnt vmcnt(12)
L_XC1:
    s_waitcnt lgkmcnt(0)
    v_xor_b32 v76, s30, v77
    v_xor_b32 v78, s30, v79
    v_min_u32 v76, v76, v78
    v_xor_b32 v80, s30, v81
    v_xor_b32 v82, s30, v83
    v_min_u32 v80, v80, v82
    v_min_u32 v76, v76, v80
    v_cmp_eq_u32 vcc, 0, v76
    s_cbranch_vccz L_XC1_OK
    s_cmp_eq_u32 s19, 0
    s_cbranch_scc1 L_XC1_OK
    s_sub_u32 s19, s19, 1
    s_sleep 2
    s_add_u32 s13, s10, 1
    s_and_b32 s13, s13, 15
    s_lshl_b32 s13, s13, 18
    s_add_u32 m0, s64, 8192
    s_nop 0
    buffer_load_dwordx4 v84, s[52:55], s13 offen sc1 lds
    s_add_u32 m0, s64, 9216
    s_nop 0
    buffer_load_dwordx4 v85, s[52:55], s13 offen sc1 lds
    s_waitcnt vmcnt(0)
    ds_read_b128 v[76:79], v89 offset:8192
    ds_read_b128 v[80:83], v89 offset:9216
    s_branch L_XC1
L_XC1_OK:
    s_barrier
    s_waitcnt vmcnt(10)
    ds_read_b128 v[76:79], v89 offset:16384
    ds_read_b128 v[80:83], v89 offset:17408
    s_add_u32 s13, s10, 6
    s_and_b32 s13, s13, 15
    s_lshl_b32 s13, s13, 18
    s_add_u32 m0, s64, 49152
    s_nop 0
    buffer_load_dwordx4 v84, s[52:55], s13 offen sc1 lds
    s_add_u32 m0, s64, 50176
    s_nop 0
    buffer_load_dwordx4 v85, s[52:55], s13 offen sc1 lds
    s_add_u32 s13, s10, 7
    s_and_b32 s13, s13, 15
    s_lshl_b32 s13, s13, 18
    s_add_u32 m0, s64, 57344
    s_nop 0
    buffer_load_dwordx4 v84, s[52:55], s13 offen sc1 lds
    s_add_u32 m0, s64, 58368
    s_nop 0
    buffer_load_dwordx4 v85, s[52:55], s13 offen sc1 lds
    s_waitcnt vmcnt(14)
L_XC2:
    s_waitcnt lgkmcnt(0)
    v_xor_b32 v76, s30, v77
    v_xor_b32 v78, s30, v79
    v_min_u32 v76, v76, v78
    v_xor_b32 v80, s30, v81
    v_xor_b32 v82, s30, v83
    v_min_u32 v80, v80, v82
    v_min_u32 v76, v76, v80
    v_cmp_eq_u32 vcc, 0, v76
    s_cbranch_vccz L_XC2_OK
    s_cmp_eq_u32 s19, 0
    s_cbranch_scc1 L_XC2_OK
    s_sub_u32 s19, s19, 1
    s_sleep 2
    s_add_u32 s13, s10, 2
    s_and_b32 s13, s13, 15
    s_lshl_b32 s13, s13, 18
    s_add_u32 m0, s64, 16384
    s_nop 0
    buffer_load_dwordx4 v84, s[52:55], s13 offen sc1 lds
    s_add_u32 m0, s64, 17408
    s_nop 0
    buffer_load_dwordx4 v85, s[52:55], s13 offen sc1 lds
    s_waitcnt vmcnt(0)
    ds_read_b128 v[76:79], v89 offset:16384
    ds_read_b128 v[80:83], v89 offset:17408
    s_branch L_XC2
L_XC2_OK:
    s_barrier
    s_waitcnt vmcnt(12)
    ds_read_b128 v[76:79], v89 offset:24576
    ds_read_b128 v[80:83], v89 offset:25600
    s_add_u32 s13, s10, 8
    s_and_b32 s13, s13, 15
    s_lshl_b32 s13, s13, 18
    s_add_u32 m0, s64, 0
    s_nop 0
    buffer_load_dwordx4 v84, s[52:55], s13 offen sc1 lds
    s_add_u32 m0, s64, 1024
    s_nop 0
    buffer_load_dwordx4 v85, s[52:55], s13 offen sc1 lds
    s_add_u32 s13, s10, 8
    s_and_b32 s13, s13, 15
    s_mul_i32 s13, s13, 88064
    s_add_u32 s13, s13, s66
    s_add_u32 m0, s67, 0
    s_nop 0
    buffer_load_dwordx4 v204, s[40:43], s13 offen lds
    s_add_u32 s13, s10, 8
    s_and_b32 s13, s13, 15
    s_mul_i32 s13, s13, 88064
    s_add_u32 s13, s13, s66
    s_add_u32 m0, s67, 1024
    s_nop 0
    buffer_load_dwordx4 v205, s[40:43], s13 offen lds
    s_waitcnt vmcnt(16)
L_XC3:
    s_waitcnt lgkmcnt(0)
    v_xor_b32 v76, s30, v77
    v_xor_b32 v78, s30, v79
    v_min_u32 v76, v76, v78
    v_xor_b32 v80, s30, v81
    v_xor_b32 v82, s30, v83
    v_min_u32 v80, v80, v82
    v_min_u32 v76, v76, v80
    v_cmp_eq_u32 vcc, 0, v76
    s_cbranch_vccz L_XC3_OK
    s_cmp_eq_u32 s19, 0
    s_cbranch_scc1 L_XC3_OK
    s_sub_u32 s19, s19, 1
    s_sleep 2
    s_add_u32 s13, s10, 3
    s_and_b32 s13, s13, 15
    s_lshl_b32 s13, s13, 18
    s_add_u32 m0, s64, 24576
    s_nop 0
    buffer_load_dwordx4 v84, s[52:55], s13 offen sc1 lds
    s_add_u32 m0, s64, 25600
    s_nop 0
    buffer_load_dwordx4 v85, s[52:55], s13 offen sc1 lds
    s_waitcnt vmcnt(0)
    ds_read_b128 v[76:79], v89 offset:24576
    ds_read_b128 v[80:83], v89 offset:25600
    s_branch L_XC3
L_XC3_OK:
    s_barrier
    s_waitcnt vmcnt(10)
    ds_read_b128 v[76:79], v89 offset:32768
    ds_read_b128 v[80:83], v89 offset:33792
    s_add_u32 s13, s10, 8
    s_and_b32 s13, s13, 15
    s_mul_i32 s13, s13, 88064
    s_add_u32 s13, s13, s66
    s_add_u32 m0, s67, 2048
    s_nop 0
    buffer_load_dwordx4 v206, s[40:43], s13 offen lds
    s_add_u32 s13, s10, 9
    s_and_b32 s13, s13, 15
    s_lshl_b32 s13, s13, 18
    s_add_u32 m0, s64, 8192
    s_nop 0
    buffer_load_dwordx4 v84, s[52:55], s13 offen sc1 lds
    s_add_u32 m0, s64, 9216
    s_nop 0
    buffer_load_dwordx4 v85, s[52:55], s13 offen sc1 lds
    s_add_u32 s13, s10, 9
    s_and_b32 s13, s13, 15
    s_mul_i32 s13, s13, 88064
    s_add_u32 s13, s13, s66
    s_add_u32 m0, s67, 12288
    s_nop 0
    buffer_load_dwordx4 v204, s[40:43], s13 offen lds
    s_waitcnt vmcnt(14)
L_XC4:
    s_waitcnt lgkmcnt(0)
    v_xor_b32 v76, s30, v77
    v_xor_b32 v78, s30, v79
    v_min_u32 v76, v76, v78
    v_xor_b32 v80, s30, v81
    v_xor_b32 v82, s30, v83
    v_min_u32 v80, v80, v82
    v_min_u32 v76, v76, v80
    v_cmp_eq_u32 vcc, 0, v76
    s_cbranch_vccz L_XC4_OK
    s_cmp_eq_u32 s19, 0
    s_cbranch_scc1 L_XC4_OK
    s_sub_u32 s19, s19, 1
    s_sleep 2
    s_add_u32 s13, s10, 4
    s_and_b32 s13, s13, 15
    s_lshl_b32 s13, s13, 18
    s_add_u32 m0, s64, 32768
    s_nop 0
    buffer_load_dwordx4 v84, s[52:55], s13 offen sc1 lds
    s_add_u32 m0, s64, 33792
    s_nop 0
    buffer_load_dwordx4 v85, s[52:55], s13 offen sc1 lds
    s_waitcnt vmcnt(0)
    ds_read_b128 v[76:79], v89 offset:32768
    ds_read_b128 v[80:83], v89 offset:33792
    s_branch L_XC4
L_XC4_OK:
    s_barrier
    s_waitcnt vmcnt(12)
    ds_read_b128 v[76:79], v89 offset:40960
    ds_read_b128 v[80:83], v89 offset:41984
    s_add_u32 s13, s10, 9
    s_and_b32 s13, s13, 15
    s_mul_i32 s13, s13, 88064
    s_add_u32 s13, s13, s66
    s_add_u32 m0, s67, 13312
    s_nop 0
    buffer_load_dwordx4 v205, s[40:43], s13 offen lds
    s_add_u32 s13, s10, 9
    s_and_b32 s13, s13, 15
    s_mul_i32 s13, s13, 88064
    s_add_u32 s13, s13, s66
    s_add_u32 m0, s67, 14336
    s_nop 0
    buffer_load_dwordx4 v206, s[40:43], s13 offen lds
    s_add_u32 s13, s10, 10
    s_and_b32 s13, s13, 15
    s_lshl_b32 s13, s13, 18
    s_add_u32 m0, s64, 16384
    s_nop 0
    buffer_load_dwordx4 v84, s[52:55], s13 offen sc1 lds
    s_add_u32 m0, s64, 17408
    s_nop 0
    buffer_load_dwordx4 v85, s[52:55], s13 offen sc1 lds
    s_waitcnt vmcnt(16)
L_XC5:
    s_waitcnt lgkmcnt(0)
    v_xor_b32 v76, s30, v77
    v_xor_b32 v78, s30, v79
    v_min_u32 v76, v76, v78
    v_xor_b32 v80, s30, v81
    v_xor_b32 v82, s30, v83
    v_min_u32 v80, v80, v82
    v_min_u32 v76, v76, v80
    v_cmp_eq_u32 vcc, 0, v76
    s_cbranch_vccz L_XC5_OK
    s_cmp_eq_u32 s19, 0
    s_cbranch_scc1 L_XC5_OK
    s_sub_u32 s19, s19, 1
    s_sleep 2
    s_add_u32 s13, s10, 5
    s_and_b32 s13, s13, 15
    s_lshl_b32 s13, s13, 18
    s_add_u32 m0, s64, 40960
    s_nop 0
    buffer_load_dwordx4 v84, s[52:55], s13 offen sc1 lds
    s_add_u32 m0, s64, 41984
    s_nop 0
    buffer_load_dwordx4 v85, s[52:55], s13 offen sc1 lds
    s_waitcnt vmcnt(0)
    ds_read_b128 v[76:79], v89 offset:40960
    ds_read_b128 v[80:83], v89 offset:41984
    s_branch L_XC5
L_XC5_OK:
    s_barrier
    s_waitcnt vmcnt(14)
    ds_read_b128 v[76:79], v89 offset:49152
    ds_read_b128 v[80:83], v89 offset:50176
    s_cmp_lg_u32 s3, 6
    s_cbranch_scc1 L_NOFP
    buffer_store_dword v72, v70, s[48:51], s57 offen sc1
L_NOFP:
    s_add_u32 s13, s10, 10
    s_and_b32 s13, s13, 15
    s_mul_i32 s13, s13, 88064
    s_add_u32 s13, s13, s66
    s_add_u32 m0, s67, 24576
    s_nop 0
    buffer_load_dwordx4 v204, s[40:43], s13 offen lds
    s_add_u32 s13, s10, 10
    s_and_b32 s13, s13, 15
    s_mul_i32 s13, s13, 88064
    s_add_u32 s13, s13, s66
    s_add_u32 m0, s67, 25600
    s_nop 0
    buffer_load_dwordx4 v205, s[40:43], s13 offen lds
    s_add_u32 s13, s10, 10
    s_and_b32 s13, s13, 15
    s_mul_i32 s13, s13, 88064
    s_add_u32 s13, s13, s66
    s_add_u32 m0, s67, 26624
    s_nop 0
    buffer_load_dwordx4 v206, s[40:43], s13 offen lds
    s_add_u32 s13, s10, 11
    s_and_b32 s13, s13, 15
    s_mul_i32 s13, s13, 88064
    s_add_u32 s13, s13, s66
    s_add_u32 m0, s67, 36864
    s_nop 0
    buffer_load_dwordx4 v204, s[40:43], s13 offen lds
    s_waitcnt vmcnt(18)
L_XC6:
    s_waitcnt lgkmcnt(0)
    v_xor_b32 v76, s30, v77
    v_xor_b32 v78, s30, v79
    v_min_u32 v76, v76, v78
    v_xor_b32 v80, s30, v81
    v_xor_b32 v82, s30, v83
    v_min_u32 v80, v80, v82
    v_min_u32 v76, v76, v80
    v_cmp_eq_u32 vcc, 0, v76
    s_cbranch_vccz L_XC6_OK
    s_cmp_eq_u32 s19, 0
    s_cbranch_scc1 L_XC6_OK
    s_sub_u32 s19, s19, 1
    s_sleep 2
    s_add_u32 s13, s10, 6
    s_and_b32 s13, s13, 15
    s_lshl_b32 s13, s13, 18
    s_add_u32 m0, s64, 49152
    s_nop 0
    buffer_load_dwordx4 v84, s[52:55], s13 offen sc1 lds
    s_add_u32 m0, s64, 50176
    s_nop 0
    buffer_load_dwordx4 v85, s[52:55], s13 offen sc1 lds
    s_waitcnt vmcnt(0)
    ds_read_b128 v[76:79], v89 offset:49152
    ds_read_b128 v[80:83], v89 offset:50176
    s_branch L_XC6
L_XC6_OK:
    s_barrier
    s_waitcnt vmcnt(16)
    ds_read_b128 v[76:79], v89 offset:57344
    ds_read_b128 v[80:83], v89 offset:58368
    s_cmp_lg_u32 s3, 4
    s_cbranch_scc1 L_NOFA
    buffer_load_dword v95, v94, s[48:51], s61 offen sc1
L_NOFA:
    s_add_u32 s13, s10, 11
    s_and_b32 s13, s13, 15
    s_lshl_b32 s13, s13, 18
    s_add_u32 m0, s64, 24576
    s_nop 0
    buffer_load_dwordx4 v84, s[52:55], s13 offen sc1 lds
    s_add_u32 m0, s64, 25600
    s_nop 0
    buffer_load_dwordx4 v85, s[52:55], s13 offen sc1 lds
    s_add_u32 s13, s10, 11
    s_and_b32 s13, s13, 15
    s_mul_i32 s13, s13, 88064
    s_add_u32 s13, s13, s66
    s_add_u32 m0, s67, 37888
    s_nop 0
    buffer_load_dwordx4 v205, s[40:43], s13 offen lds
    s_add_u32 s13, s10, 11
    s_and_b32 s13, s13, 15
    s_mul_i32 s13, s13, 88064
    s_add_u32 s13, s13, s66
    s_add_u32 m0, s67, 38912
    s_nop 0
    buffer_load_dwordx4 v206, s[40:43], s13 offen lds
    s_waitcnt vmcnt(20)
L_XC7:
    s_waitcnt lgkmcnt(0)
    v_xor_b32 v76, s30, v77
    v_xor_b32 v78, s30, v79
    v_min_u32 v76, v76, v78
    v_xor_b32 v80, s30, v81
    v_xor_b32 v82, s30, v83
    v_min_u32 v80, v80, v82
    v_min_u32 v76, v76, v80
    v_cmp_eq_u32 vcc, 0, v76
    s_cbranch_vccz L_XC7_OK
    s_cmp_eq_u32 s19, 0
    s_cbranch_scc1 L_XC7_OK
    s_sub_u32 s19, s19, 1
    s_sleep 2
    s_add_u32 s13, s10, 7
    s_and_b32 s13, s13, 15
    s_lshl_b32 s13, s13, 18
    s_add_u32 m0, s64, 57344
    s_nop 0
    buffer_load_dwordx4 v84, s[52:55], s13 offen sc1 lds
    s_add_u32 m0, s64, 58368
    s_nop 0
    buffer_load_dwordx4 v85, s[52:55], s13 offen sc1 lds
    s_waitcnt vmcnt(0)
    ds_read_b128 v[76:79], v89 offset:57344
    ds_read_b128 v[80:83], v89 offset:58368
    s_branch L_XC7
L_XC7_OK:
    s_barrier
    s_waitcnt vmcnt(18)
    ds_read_b128 v[76:79], v89 offset:0
    ds_read_b128 v[80:83], v89 offset:1024
    s_add_u32 s13, s10, 12
    s_and_b32 s13, s13, 15
    s_lshl_b32 s13, s13, 18
    s_add_u32 m0, s64, 32768
    s_nop 0
    buffer_load_dwordx4 v84, s[52:55], s13 offen sc1 lds
    s_add_u32 m0, s64, 33792
    s_nop 0
    buffer_load_dwordx4 v85, s[52:55], s13 offen sc1 lds
    s_add_u32 s13, s10, 12
    s_and_b32 s13, s13, 15
    s_mul_i32 s13, s13, 88064
    s_add_u32 s13, s13, s66
    s_add_u32 m0, s67, 49152
    s_nop 0
    buffer_load_dwordx4 v204, s[40:43], s13 offen lds
    s_add_u32 s13, s10, 12
    s_and_b32 s13, s13, 15
    s_mul_i32 s13, s13, 88064
    s_add_u32 s13, s13, s66
    s_add_u32 m0, s67, 50176
    s_nop 0
    buffer_load_dwordx4 v205, s[40:43], s13 offen lds
    s_waitcnt vmcnt(19)
L_XC8:
    s_waitcnt lgkmcnt(0)
    v_xor_b32 v76, s30, v77
    v_xor_b32 v78, s30, v79
    v_min_u32 v76, v76, v78
    v_xor_b32 v80, s30, v81
    v_xor_b32 v82, s30, v83
    v_min_u32 v80, v80, v82
    v_min_u32 v76, v76, v80
    v_cmp_eq_u32 vcc, 0, v76
    s_cbranch_vccz L_XC8_OK
    s_cmp_eq_u32 s19, 0
    s_cbranch_scc1 L_XC8_OK
    s_sub_u32 s19, s19, 1
    s_sleep 2
    s_add_u32 s13, s10, 8
    s_and_b32 s13, s13, 15
    s_lshl_b32 s13, s13, 18
    s_add_u32 m0, s64, 0
    s_nop 0
    buffer_load_dwordx4 v84, s[52:55], s13 offen sc1 lds
    s_add_u32 m0, s64, 1024
    s_nop 0
    buffer_load_dwordx4 v85, s[52:55], s13 offen sc1 lds
    s_waitcnt vmcnt(0)
    ds_read_b128 v[76:79], v89 offset:0
    ds_read_b128 v[80:83], v89 offset:1024
    s_branch L_XC8
L_XC8_OK:
    s_cmp_lg_u32 s3, 4
    s_cbranch_scc1 L_AUGOK
    s_waitcnt vmcnt(8)
    s_branch L_POLL1_C
L_POLL1:
    buffer_load_dword v95, v94, s[48:51], s61 offen sc1
    s_waitcnt vmcnt(0)
L_POLL1_C:
    v_cmp_ne_u32 vcc, s30, v95
    s_nop 0
    s_cmp_eq_u64 vcc, 0
    s_cbranch_scc1 L_POLL1_OK
    s_cmp_eq_u32 s19, 0
    s_cbranch_scc1 L_POLL1_OK
    s_sub_u32 s19, s19, 1
    s_sleep 2
    s_branch L_POLL1
L_POLL1_OK:
L_AUGOK:
    s_barrier
    s_waitcnt vmcnt(17)
    ds_read_b128 v[76:79], v89 offset:8192
    ds_read_b128 v[80:83], v89 offset:9216
    s_add_u32 s13, s10, 12
    s_and_b32 s13, s13, 15
    s_mul_i32 s13, s13, 88064
    s_add_u32 s13, s13, s66
    s_add_u32 m0, s67, 51200
    s_nop 0
    buffer_load_dwordx4 v206, s[40:43], s13 offen lds
    s_add_u32 s13, s10, 13
    s_and_b32 s13, s13, 15
    s_lshl_b32 s13, s13, 18
    s_add_u32 m0, s64, 40960
    s_nop 0
    buffer_load_dwordx4 v84, s[52:55], s13 offen sc1 lds
    s_add_u32 m0, s64, 41984
    s_nop 0
    buffer_load_dwordx4 v85, s[52:55], s13 offen sc1 lds
    s_add_u32 s13, s10, 13
    s_and_b32 s13, s13, 15
    s_mul_i32 s13, s13, 88064
    s_add_u32 s13, s13, s66
    s_add_u32 m0, s67, 61440
    s_nop 0
    buffer_load_dwordx4 v204, s[40:43], s13 offen lds
    s_waitcnt vmcnt(18)
L_XC9:
    s_waitcnt lgkmcnt(0)
    v_xor_b32 v76, s30, v77
    v_xor_b32 v78, s30, v79
    v_min_u32 v76, v76, v78
    v_xor_b32 v80, s30, v81
    v_xor_b32 v82, s30, v83
    v_min_u32 v80, v80, v82
    v_min_u32 v76, v76, v80
    v_cmp_eq_u32 vcc, 0, v76
    s_cbranch_vccz L_XC9_OK
    s_cmp_eq_u32 s19, 0
    s_cbranch_scc1 L_XC9_OK
    s_sub_u32 s19, s19, 1
    s_sleep 2
    s_add_u32 s13, s10, 9
    s_and_b32 s13, s13, 15
    s_lshl_b32 s13, s13, 18
    s_add_u32 m0, s64, 8192
    s_nop 0
    buffer_load_dwordx4 v84, s[52:55], s13 offen sc1 lds
    s_add_u32 m0, s64, 9216
    s_nop 0
    buffer_load_dwordx4 v85, s[52:55], s13 offen sc1 lds
    s_waitcnt vmcnt(0)
    ds_read_b128 v[76:79], v89 offset:8192
    ds_read_b128 v[80:83], v89 offset:9216
    s_branch L_XC9
L_XC9_OK:
    s_barrier
    s_waitcnt vmcnt(16)
    ds_read_b128 v[76:79], v89 offset:16384
    ds_read_b128 v[80:83], v89 offset:17408
    s_add_u32 s13, s10, 13
    s_and_b32 s13, s13, 15
    s_mul_i32 s13, s13, 88064
    s_add_u32 s13, s13, s66
    s_add_u32 m0, s67, 62464
    s_nop 0
    buffer_load_dwordx4 v205, s[40:43], s13 offen lds
    s_add_u32 s13, s10, 13
    s_and_b32 s13, s13, 15
    s_mul_i32 s13, s13, 88064
    s_add_u32 s13, s13, s66
    s_add_u32 m0, s67, 63488
    s_nop 0
    buffer_load_dwordx4 v206, s[40:43], s13 offen lds
    s_add_u32 s13, s10, 14
    s_and_b32 s13, s13, 15
    s_lshl_b32 s13, s13, 18
    s_add_u32 m0, s64, 49152
    s_nop 0
    buffer_load_dwordx4 v84, s[52:55], s13 offen sc1 lds
    s_add_u32 m0, s64, 50176
    s_nop 0
    buffer_load_dwordx4 v85, s[52:55], s13 offen sc1 lds
    s_waitcnt vmcnt(17)
L_XC10:
    s_waitcnt lgkmcnt(0)
    v_xor_b32 v76, s30, v77
    v_xor_b32 v78, s30, v79
    v_min_u32 v76, v76, v78
    v_xor_b32 v80, s30, v81
    v_xor_b32 v82, s30, v83
    v_min_u32 v80, v80, v82
    v_min_u32 v76, v76, v80
    v_cmp_eq_u32 vcc, 0, v76
    s_cbranch_vccz L_XC10_OK
    s_cmp_eq_u32 s19, 0
    s_cbranch_scc1 L_XC10_OK
    s_sub_u32 s19, s19, 1
    s_sleep 2
    s_add_u32 s13, s10, 10
    s_and_b32 s13, s13, 15
    s_lshl_b32 s13, s13, 18
    s_add_u32 m0, s64, 16384
    s_nop 0
    buffer_load_dwordx4 v84, s[52:55], s13 offen sc1 lds
    s_add_u32 m0, s64, 17408
    s_nop 0
    buffer_load_dwordx4 v85, s[52:55], s13 offen sc1 lds
    s_waitcnt vmcnt(0)
    ds_read_b128 v[76:79], v89 offset:16384
    ds_read_b128 v[80:83], v89 offset:17408
    s_branch L_XC10
L_XC10_OK:
    s_barrier
    s_waitcnt vmcnt(14)
    ds_read_b128 v[76:79], v89 offset:24576
    ds_read_b128 v[80:83], v89 offset:25600
    s_add_u32 s13, s10, 14
    s_and_b32 s13, s13, 15
    s_mul_i32 s13, s13, 88064
    s_add_u32 s13, s13, s66
    s_add_u32 m0, s67, 73728
    s_nop 0
    buffer_load_dwordx4 v204, s[40:43], s13 offen lds
    s_add_u32 s13, s10, 14
    s_and_b32 s13, s13, 15
    s_mul_i32 s13, s13, 88064
    s_add_u32 s13, s13, s66
    s_add_u32 m0, s67, 74752
    s_nop 0
    buffer_load_dwordx4 v205, s[40:43], s13 offen lds
    s_add_u32 s13, s10, 14
    s_and_b32 s13, s13, 15
    s_mul_i32 s13, s13, 88064
    s_add_u32 s13, s13, s66
    s_add_u32 m0, s67, 75776
    s_nop 0
    buffer_load_dwordx4 v206, s[40:43], s13 offen lds
    s_add_u32 s13, s10, 15
    s_and_b32 s13, s13, 15
    s_mul_i32 s13, s13, 88064
    s_add_u32 s13, s13, s66
    s_add_u32 m0, s67, 86016
    s_nop 0
    buffer_load_dwordx4 v204, s[40:43], s13 offen lds
    s_waitcnt vmcnt(16)
L_XC11:
    s_waitcnt lgkmcnt(0)
    v_xor_b32 v76, s30, v77
    v_xor_b32 v78, s30, v79
    v_min_u32 v76, v76, v78
    v_xor_b32 v80, s30, v81
    v_xor_b32 v82, s30, v83
    v_min_u32 v80, v80, v82
    v_min_u32 v76, v76, v80
    v_cmp_eq_u32 vcc, 0, v76
    s_cbranch_vccz L_XC11_OK
    s_cmp_eq_u32 s19, 0
    s_cbranch_scc1 L_XC11_OK
    s_sub_u32 s19, s19, 1
    s_sleep 2
    s_add_u32 s13, s10, 11
    s_and_b32 s13, s13, 15
    s_lshl_b32 s13, s13, 18
    s_add_u32 m0, s64, 24576
    s_nop 0
    buffer_load_dwordx4 v84, s[52:55], s13 offen sc1 lds
    s_add_u32 m0, s64, 25600
    s_nop 0
    buffer_load_dwordx4 v85, s[52:55], s13 offen sc1 lds
    s_waitcnt vmcnt(0)
    ds_read_b128 v[76:79], v89 offset:24576
    ds_read_b128 v[80:83], v89 offset:25600
    s_branch L_XC11
L_XC11_OK:
    s_barrier
    s_waitcnt vmcnt(14)
    ds_read_b128 v[76:79], v89 offset:32768
    ds_read_b128 v[80:83], v89 offset:33792
    s_add_u32 s13, s10, 15
    s_and_b32 s13, s13, 15
    s_lshl_b32 s13, s13, 18
    s_add_u32 m0, s64, 57344
    s_nop 0
    buffer_load_dwordx4 v84, s[52:55], s13 offen sc1 lds
    s_add_u32 m0, s64, 58368
    s_nop 0
    buffer_load_dwordx4 v85, s[52:55], s13 offen sc1 lds
    s_add_u32 s13, s10, 15
    s_and_b32 s13, s13, 15
    s_mul_i32 s13, s13, 88064
    s_add_u32 s13, s13, s66
    s_add_u32 m0, s67, 87040
    s_nop 0
    buffer_load_dwordx4 v205, s[40:43], s13 offen lds
    s_add_u32 s13, s10, 15
    s_and_b32 s13, s13, 15
    s_mul_i32 s13, s13, 88064
    s_add_u32 s13, s13, s66
    s_add_u32 m0, s67, 88064
    s_nop 0
    buffer_load_dwordx4 v206, s[40:43], s13 offen lds
    s_waitcnt vmcnt(15)
L_XC12:
    s_waitcnt lgkmcnt(0)
    v_xor_b32 v76, s30, v77
    v_xor_b32 v78, s30, v79
    v_min_u32 v76, v76, v78
    v_xor_b32 v80, s30, v81
    v_xor_b32 v82, s30, v83
    v_min_u32 v80, v80, v82
    v_min_u32 v76, v76, v80
    v_cmp_eq_u32 vcc, 0, v76
    s_cbranch_vccz L_XC12_OK
    s_cmp_eq_u32 s19, 0
    s_cbranch_scc1 L_XC12_OK
    s_sub_u32 s19, s19, 1
    s_sleep 2
    s_add_u32 s13, s10, 12
    s_and_b32 s13, s13, 15
    s_lshl_b32 s13, s13, 18
    s_add_u32 m0, s64, 32768
    s_nop 0
    buffer_load_dwordx4 v84, s[52:55], s13 offen sc1 lds
    s_add_u32 m0, s64, 33792
    s_nop 0
    buffer_load_dwordx4 v85, s[52:55], s13 offen sc1 lds
    s_waitcnt vmcnt(0)
    ds_read_b128 v[76:79], v89 offset:32768
    ds_read_b128 v[80:83], v89 offset:33792
    s_branch L_XC12
L_XC12_OK:
    s_barrier
    s_waitcnt vmcnt(13)
    ds_read_b128 v[76:79], v89 offset:40960
    ds_read_b128 v[80:83], v89 offset:41984
    s_add_u32 s13, s60, 0
    s_add_u32 m0, s64, 0
    s_nop 0
    buffer_load_dwordx4 v13, s[36:39], s13 offen lds
    s_add_u32 s13, s60, 8192
    s_add_u32 m0, s64, 1024
    s_nop 0
    buffer_load_dwordx4 v13, s[36:39], s13 offen lds
    s_add_u32 s13, s60, 49152
    s_add_u32 m0, s64, 65536
    s_nop 0
    buffer_load_dwordx4 v13, s[36:39], s13 offen lds
    s_add_u32 s13, s60, 57344
    s_add_u32 m0, s64, 66560
    s_nop 0
    buffer_load_dwordx4 v13, s[36:39], s13 offen lds
    s_add_u32 s13, s60, 98304
    s_add_u32 m0, s64, 8192
    s_nop 0
    buffer_load_dwordx4 v13, s[36:39], s13 offen lds
    s_waitcnt vmcnt(15)
L_XC13:
    s_waitcnt lgkmcnt(0)
    v_xor_b32 v76, s30, v77
    v_xor_b32 v78, s30, v79
    v_min_u32 v76, v76, v78
    v_xor_b32 v80, s30, v81
    v_xor_b32 v82, s30, v83
    v_min_u32 v80, v80, v82
    v_min_u32 v76, v76, v80
    v_cmp_eq_u32 vcc, 0, v76
    s_cbranch_vccz L_XC13_OK
    s_cmp_eq_u32 s19, 0
    s_cbranch_scc1 L_XC13_OK
    s_sub_u32 s19, s19, 1
    s_sleep 2
    s_add_u32 s13, s10, 13
    s_and_b32 s13, s13, 15
    s_lshl_b32 s13, s13, 18
    s_add_u32 m0, s64, 40960
    s_nop 0
    buffer_load_dwordx4 v84, s[52:55], s13 offen sc1 lds
    s_add_u32 m0, s64, 41984
    s_nop 0
    buffer_load_dwordx4 v85, s[52:55], s13 offen sc1 lds
    s_waitcnt vmcnt(0)
    ds_read_b128 v[76:79], v89 offset:40960
    ds_read_b128 v[80:83], v89 offset:41984
    s_branch L_XC13
L_XC13_OK:
    s_barrier
    s_waitcnt vmcnt(13)
    ds_read_b128 v[76:79], v89 offset:49152
    ds_read_b128 v[80:83], v89 offset:50176
    s_add_u32 s13, s60, 106496
    s_add_u32 m0, s64, 9216
    s_nop 0
    buffer_load_dwordx4 v13, s[36:39], s13 offen lds
    s_add_u32 s13, s60, 147456
    s_add_u32 m0, s64, 73728
    s_nop 0
    buffer_load_dwordx4 v13, s[36:39], s13 offen lds
    s_add_u32 s13, s60, 155648
    s_add_u32 m0, s64, 74752
    s_nop 0
    buffer_load_dwordx4 v13, s[36:39], s13 offen lds
    s_add_u32 s13, s60, 196608
    s_add_u32 m0, s64, 81920
    s_nop 0
    buffer_load_dwordx4 v13, s[36:39], s13 offen lds
    s_add_u32 s13, s60, 204800
    s_add_u32 m0, s64, 82944
    s_nop 0
    buffer_load_dwordx4 v13, s[36:39], s13 offen lds
    s_waitcnt vmcnt(15)
L_XC14:
    s_waitcnt lgkmcnt(0)
    v_xor_b32 v76, s30, v77
    v_xor_b32 v78, s30, v79
    v_min_u32 v76, v76, v78
    v_xor_b32 v80, s30, v81
    v_xor_b32 v82, s30, v83
    v_min_u32 v80, v80, v82
    v_min_u32 v76, v76, v80
    v_cmp_eq_u32 vcc, 0, v76
    s_cbranch_vccz L_XC14_OK
    s_cmp_eq_u32 s19, 0
    s_cbranch_scc1 L_XC14_OK
    s_sub_u32 s19, s19, 1
    s_sleep 2
    s_add_u32 s13, s10, 14
    s_and_b32 s13, s13, 15
    s_lshl_b32 s13, s13, 18
    s_add_u32 m0, s64, 49152
    s_nop 0
    buffer_load_dwordx4 v84, s[52:55], s13 offen sc1 lds
    s_add_u32 m0, s64, 50176
    s_nop 0
    buffer_load_dwordx4 v85, s[52:55], s13 offen sc1 lds
    s_waitcnt vmcnt(0)
    ds_read_b128 v[76:79], v89 offset:49152
    ds_read_b128 v[80:83], v89 offset:50176
    s_branch L_XC14
L_XC14_OK:
    s_barrier
    s_waitcnt vmcnt(12)
    ds_read_b128 v[76:79], v89 offset:57344
    ds_read_b128 v[80:83], v89 offset:58368
    s_add_u32 s13, s60, 245760
    s_add_u32 m0, s64, 16384
    s_nop 0
    buffer_load_dwordx4 v13, s[36:39], s13 offen lds
    s_add_u32 s13, s60, 253952
    s_add_u32 m0, s64, 17408
    s_nop 0
    buffer_load_dwordx4 v13, s[36:39], s13 offen lds
    s_add_u32 s13, s60, 294912
    s_add_u32 m0, s64, 90112
    s_nop 0
    buffer_load_dwordx4 v13, s[36:39], s13 offen lds
    s_add_u32 s13, s60, 303104
    s_add_u32 m0, s64, 91136
    s_nop 0
    buffer_load_dwordx4 v13, s[36:39], s13 offen lds
    s_add_u32 s13, s60, 16384
    s_add_u32 m0, s64, 24576
    s_nop 0
    buffer_load_dwordx4 v13, s[36:39], s13 offen lds
    s_waitcnt vmcnt(15)
L_XC15:
    s_waitcnt lgkmcnt(0)
    v_xor_b32 v76, s30, v77
    v_xor_b32 v78, s30, v79
    v_min_u32 v76, v76, v78
    v_xor_b32 v80, s30, v81
    v_xor_b32 v82, s30, v83
    v_min_u32 v80, v80, v82
    v_min_u32 v76, v76, v80
    v_cmp_eq_u32 vcc, 0, v76
    s_cbranch_vccz L_XC15_OK
    s_cmp_eq_u32 s19, 0
    s_cbranch_scc1 L_XC15_OK
    s_sub_u32 s19, s19, 1
    s_sleep 2
    s_add_u32 s13, s10, 15
    s_and_b32 s13, s13, 15
    s_lshl_b32 s13, s13, 18
    s_add_u32 m0, s64, 57344
    s_nop 0
    buffer_load_dwordx4 v84, s[52:55], s13 offen sc1 lds
    s_add_u32 m0, s64, 58368
    s_nop 0
    buffer_load_dwordx4 v85, s[52:55], s13 offen sc1 lds
    s_waitcnt vmcnt(0)
    ds_read_b128 v[76:79], v89 offset:57344
    ds_read_b128 v[80:83], v89 offset:58368
    s_branch L_XC15
L_XC15_OK:
    s_barrier
    s_add_u32 s13, s60, 24576
    s_add_u32 m0, s64, 25600
    s_nop 0
    buffer_load_dwordx4 v13, s[36:39], s13 offen lds
    s_add_u32 s13, s60, 65536
    s_add_u32 m0, s64, 98304
    s_nop 0
    buffer_load_dwordx4 v13, s[36:39], s13 offen lds
    s_add_u32 s13, s60, 73728
    s_add_u32 m0, s64, 99328
    s_nop 0
    buffer_load_dwordx4 v13, s[36:39], s13 offen lds
    s_add_u32 s13, s60, 114688
    s_add_u32 m0, s64, 106496
    s_nop 0
    buffer_load_dwordx4 v13, s[36:39], s13 offen lds
    s_add_u32 s13, s60, 122880
    s_add_u32 m0, s64, 107520
    s_nop 0
    buffer_load_dwordx4 v13, s[36:39], s13 offen lds
    s_barrier
    s_or_b32 s13, s2, s11
    s_cbranch_scc1 L_NOBUMP
    v_mov_b32 v91, s30
    v_mov_b32 v90, 0
    s_mov_b32 s13, 126976
    buffer_store_dword v91, v90, s[48:51], s13 offen
L_NOBUMP:
    s_add_u32 s13, s60, 163840
    s_add_u32 m0, s64, 32768
    s_nop 0
    buffer_load_dwordx4 v13, s[36:39], s13 offen lds
    s_add_u32 s13, s60, 172032
    s_add_u32 m0, s64, 33792
    s_nop 0
    buffer_load_dwordx4 v13, s[36:39], s13 offen lds
    s_add_u32 s13, s60, 212992
    s_add_u32 m0, s64, 114688
    s_nop 0
    buffer_load_dwordx4 v13, s[36:39], s13 offen lds
    s_add_u32 s13, s60, 221184
    s_add_u32 m0, s64, 115712
    s_nop 0
    buffer_load_dwordx4 v13, s[36:39], s13 offen lds
    s_add_u32 s13, s60, 262144
    s_add_u32 m0, s64, 40960
    s_nop 0
    buffer_load_dwordx4 v13, s[36:39], s13 offen lds
    s_add_u32 s13, s60, 270336
    s_add_u32 m0, s64, 41984
    s_nop 0
    buffer_load_dwordx4 v13, s[36:39], s13 offen lds
    s_add_u32 s13, s60, 311296
    s_add_u32 m0, s64, 122880
    s_nop 0
    buffer_load_dwordx4 v13, s[36:39], s13 offen lds
    s_add_u32 s13, s60, 319488
    s_add_u32 m0, s64, 123904
    s_nop 0
    buffer_load_dwordx4 v13, s[36:39], s13 offen lds
L_HG2:
    s_cmp_lg_u32 s3, 6
    s_cbranch_scc1 L_FPOK
L_POLL2:
    buffer_load_dword v69, v71, s[48:51], s58 offen sc1
    s_waitcnt vmcnt(0)
L_POLL2_C:
    v_cmp_ne_u32 vcc, s30, v69
    s_nop 0
    s_cmp_eq_u64 vcc, 0
    s_cbranch_scc1 L_POLL2_OK
    s_cmp_eq_u32 s19, 0
    s_cbranch_scc1 L_POLL2_OK
    s_sub_u32 s19, s19, 1
    s_sleep 4
    s_branch L_POLL2
L_POLL2_OK:
L_FPOK:
    s_lshr_b32 s31, s3, 2
    s_lshl_b32 s20, s8, 1
    s_add_u32 s20, s20, s31
    s_mul_i32 s4, s20, 59392
    v_add_u32 v155, s4, v6
    s_lshl_b32 s20, s20, 2
    s_add_u32 s20, s20, s11
    s_mul_i32 s20, s20, 7
    s_mul_i32 s4, s11, 14336
    s_and_b32 s5, s11, 1
    s_add_u32 s5, s5, 84
    s_lshl_b32 s18, s31, 13
    s_mul_i32 s16, s11, 344064
    s_add_u32 s16, s16, s18
    s_lshl_b32 s17, s5, 14
    s_add_u32 s17, s17, s18
    s_sub_u32 s5, s5, 28
    s_lshl_b32 s5, s5, 10
    s_lshl_b32 s21, s11, 11
    s_lshl_b32 s18, s31, 10
    s_add_u32 s18, s18, s21
    v_lshl_add_u32 v14, v3, 3, v4
    v_lshlrev_b32 v14, 7, v14
    v_lshl_add_u32 v14, v2, 5, v14
    v_lshl_add_u32 v14, v5, 3, v14
    v_add_u32 v14, s21, v14
    v_lshrrev_b32 v12, 1, v4
    v_lshl_add_u32 v8, v12, 6, v14
    v_xor_b32_e64 v12, 1, v12
    v_lshl_add_u32 v10, v12, 6, v14
    v_add_u32 v11, 65536, v8
    v_add_u32 v12, 65536, v10
    v_add_u32 v14, 131072, v8
    v_add_u32 v154, 131072, v10
    s_setprio 0
    s_waitcnt vmcnt(0)
    s_branch L_G2
L_W2ALL:
    s_lshr_b32 s58, s8, 1
    s_lshl_b32 s58, s58, 6
    s_add_u32 s58, s58, 165888
    v_min_u32 v71, 14, v1
    v_lshlrev_b32 v71, 2, v71
    s_add_u32 s13, s60, 0
    s_add_u32 m0, s64, 0
    s_nop 0
    buffer_load_dwordx4 v13, s[36:39], s13 offen lds
    s_add_u32 s13, s60, 8192
    s_add_u32 m0, s64, 1024
    s_nop 0
    buffer_load_dwordx4 v13, s[36:39], s13 offen lds
    s_add_u32 s13, s60, 49152
    s_add_u32 m0, s64, 65536
    s_nop 0
    buffer_load_dwordx4 v13, s[36:39], s13 offen lds
    s_add_u32 s13, s60, 57344
    s_add_u32 m0, s64, 66560
    s_nop 0
    buffer_load_dwordx4 v13, s[36:39], s13 offen lds
    s_add_u32 s13, s60, 98304
    s_add_u32 m0, s64, 8192
    s_nop 0
    buffer_load_dwordx4 v13, s[36:39], s13 offen lds
    s_add_u32 s13, s60, 106496
    s_add_u32 m0, s64, 9216
    s_nop 0
    buffer_load_dwordx4 v13, s[36:39], s13 offen lds
    s_add_u32 s13, s60, 147456
    s_add_u32 m0, s64, 73728
    s_nop 0
    buffer_load_dwordx4 v13, s[36:39], s13 offen lds
    s_add_u32 s13, s60, 155648
    s_add_u32 m0, s64, 74752
    s_nop 0
    buffer_load_dwordx4 v13, s[36:39], s13 offen lds
    s_add_u32 s13, s60, 196608
    s_add_u32 m0, s64, 81920
    s_nop 0
    buffer_load_dwordx4 v13, s[36:39], s13 offen lds
    s_add_u32 s13, s60, 204800
    s_add_u32 m0, s64, 82944
    s_nop 0
    buffer_load_dwordx4 v13, s[36:39], s13 offen lds
    s_add_u32 s13, s60, 245760
    s_add_u32 m0, s64, 16384
    s_nop 0
    buffer_load_dwordx4 v13, s[36:39], s13 offen lds
    s_add_u32 s13, s60, 253952
    s_add_u32 m0, s64, 17408
    s_nop 0
    buffer_load_dwordx4 v13, s[36:39], s13 offen lds
    s_add_u32 s13, s60, 294912
    s_add_u32 m0, s64, 90112
    s_nop 0
    buffer_load_dwordx4 v13, s[36:39], s13 offen lds
    s_add_u32 s13, s60, 303104
    s_add_u32 m0, s64, 91136
    s_nop 0
    buffer_load_dwordx4 v13, s[36:39], s13 offen lds
    s_add_u32 s13, s60, 16384
    s_add_u32 m0, s64, 24576
    s_nop 0
    buffer_load_dwordx4 v13, s[36:39], s13 offen lds
    s_add_u32 s13, s60, 24576
    s_add_u32 m0, s64, 25600
    s_nop 0
    buffer_load_dwordx4 v13, s[36:39], s13 offen lds
    s_add_u32 s13, s60, 65536
    s_add_u32 m0, s64, 98304
    s_nop 0
    buffer_load_dwordx4 v13, s[36:39], s13 offen lds
    s_add_u32 s13, s60, 73728
    s_add_u32 m0, s64, 99328
    s_nop 0
    buffer_load_dwordx4 v13, s[36:39], s13 offen lds
    s_add_u32 s13, s60, 114688
    s_add_u32 m0, s64, 106496
    s_nop 0
    buffer_load_dwordx4 v13, s[36:39], s13 offen lds
    s_add_u32 s13, s60, 122880
    s_add_u32 m0, s64, 107520
    s_nop 0
    buffer_load_dwordx4 v13, s[36:39], s13 offen lds
    s_add_u32 s13, s60, 163840
    s_add_u32 m0, s64, 32768
    s_nop 0
    buffer_load_dwordx4 v13, s[36:39], s13 offen lds
    s_add_u32 s13, s60, 172032
    s_add_u32 m0, s64, 33792
    s_nop 0
    buffer_load_dwordx4 v13, s[36:39], s13 offen lds
    s_add_u32 s13, s60, 212992
    s_add_u32 m0, s64, 114688
    s_nop 0
    buffer_load_dwordx4 v13, s[36:39], s13 offen lds
    s_add_u32 s13, s60, 221184
    s_add_u32 m0, s64, 115712
    s_nop 0
    buffer_load_dwordx4 v13, s[36:39], s13 offen lds
    s_add_u32 s13, s60, 262144
    s_add_u32 m0, s64, 40960
    s_nop 0
    buffer_load_dwordx4 v13, s[36:39], s13 offen lds
    s_add_u32 s13, s60, 270336
    s_add_u32 m0, s64, 41984
    s_nop 0
    buffer_load_dwordx4 v13, s[36:39], s13 offen lds
    s_add_u32 s13, s60, 311296
    s_add_u32 m0, s64, 122880
    s_nop 0
    buffer_load_dwordx4 v13, s[36:39], s13 offen lds
    s_add_u32 s13, s60, 319488
    s_add_u32 m0, s64, 123904
    s_nop 0
    buffer_load_dwordx4 v13, s[36:39], s13 offen lds
    s_and_b32 s13, s9, 3
    s_lshl_b32 s13, s13, 2
    s_add_u32 s13, s13, s11
    s_mul_i32 s13, s13, 88064
    v_lshrrev_b32 v26, 2, v1
    v_lshlrev_b32 v26, 10, v26
    v_lshl_add_u32 v26, v5, 7, v26
    s_waitcnt vmcnt(0)
    s_cmp_lg_u32 s3, 6
    s_cbranch_scc1 L_HG2
    s_lshl_b32 s14, s8, 7
    s_add_u32 s14, s14, 196608
    v_mov_b32 v27, 0
L_POLL3:
    buffer_load_dword v26, v27, s[48:51], s14 offen sc1
    s_waitcnt vmcnt(0)
L_POLL3_C:
    v_cmp_ne_u32 vcc, s30, v26
    s_nop 0
    s_cmp_eq_u64 vcc, 0
    s_cbranch_scc1 L_POLL3_OK
    s_cmp_eq_u32 s19, 0
    s_cbranch_scc1 L_POLL3_OK
    s_sub_u32 s19, s19, 1
    s_sleep 8
    s_branch L_POLL3
L_POLL3_OK:
    s_branch L_HG2
L_STATS_H:
    s_waitcnt vmcnt(0)
L_STATS_G1:
    s_barrier
L_STATS:
    s_lshl_b32 s57, s3, 14
    s_add_u32 s56, s10, s3
    s_add_u32 s56, s56, 10
    s_and_b32 s56, s56, 15
    s_lshl_b32 s56, s56, 18
    s_mov_b32 s59, 0
    v_add_u32 v64, s59, v3
    v_add_u32 v14, s6, v64
    v_and_b32_e64 v14, 15, v14
    v_lshl_add_u32 v14, v14, 9, v7
    v_lshl_add_u32 v64, v64, 14, v14
    s_mov_b32 s59, 2
    v_add_u32 v65, s59, v3
    v_add_u32 v14, s6, v65
    v_and_b32 v14, 15, v14
    v_lshl_add_u32 v14, v14, 9, v7
    v_lshl_add_u32 v65, v65, 14, v14
    s_mov_b32 s59, 4
    v_add_u32 v66, s59, v3
    v_add_u32 v14, s6, v66
    v_and_b32 v14, 15, v14
    v_lshl_add_u32 v14, v14, 9, v7
    v_lshl_add_u32 v66, v66, 14, v14
    s_mov_b32 s59, 6
    v_add_u32 v67, s59, v3
    v_add_u32 v14, s6, v67
    v_and_b32 v14, 15, v14
    v_lshl_add_u32 v14, v14, 9, v7
    v_lshl_add_u32 v67, v67, 14, v14
    s_mov_b32 s59, 8
    v_add_u32 v68, s59, v3
    v_add_u32 v14, s6, v68
    v_and_b32 v14, 15, v14
    v_lshl_add_u32 v14, v14, 9, v7
    v_lshl_add_u32 v68, v68, 14, v14
    s_mov_b32 s59, 10
    v_add_u32 v69, s59, v3
    v_add_u32 v14, s6, v69
    v_and_b32 v14, 15, v14
    v_lshl_add_u32 v14, v14, 9, v7
    v_lshl_add_u32 v69, v69, 14, v14
    s_mov_b32 s59, 12
    v_add_u32 v70, s59, v3
    v_add_u32 v14, s6, v70
    v_and_b32 v14, 15, v14
    v_lshl_add_u32 v14, v14, 9, v7
    v_lshl_add_u32 v70, v70, 14, v14
    s_mov_b32 s59, 14
    v_add_u32 v71, s59, v3
    v_add_u32 v14, s6, v71
    v_and_b32 v14, 15, v14
    v_lshl_add_u32 v14, v14, 9, v7
    v_lshl_add_u32 v71, v71, 14, v14
    s_add_u32 s59, s56, 0
    s_add_u32 m0, s57, 0
    s_nop 0
    buffer_load_dwordx4 v64, s[52:55], s59 offen sc1 lds
    s_add_u32 m0, s57, 1024
    s_nop 0
    buffer_load_dwordx4 v65, s[52:55], s59 offen sc1 lds
    s_add_u32 m0, s57, 2048
    s_nop 0
    buffer_load_dwordx4 v66, s[52:55], s59 offen sc1 lds
    s_add_u32 m0, s57, 3072
    s_nop 0
    buffer_load_dwordx4 v67, s[52:55], s59 offen sc1 lds
    s_add_u32 s59, s56, 0
    s_add_u32 m0, s57, 4096
    s_nop 0
    buffer_load_dwordx4 v68, s[52:55], s59 offen sc1 lds
    s_add_u32 m0, s57, 5120
    s_nop 0
    buffer_load_dwordx4 v69, s[52:55], s59 offen sc1 lds
    s_add_u32 m0, s57, 6144
    s_nop 0
    buffer_load_dwordx4 v70, s[52:55], s59 offen sc1 lds
    s_add_u32 m0, s57, 7168
    s_nop 0
    buffer_load_dwordx4 v71, s[52:55], s59 offen sc1 lds
    v_add_u32 v19, s57, v6
    v_lshl_add_u32 v16, v3, 3, v4
    v_lshlrev_b32_e64 v17, 8, v16
    v_lshl_add_u32 v17, v2, 5, v17
    v_lshl_add_u32 v17, v5, 3, v17
    v_add_u32 v17, s57, v17
    v_xor_b32 v18, 0, v4
    v_lshl_add_u32 v20, v18, 6, v17
    v_xor_b32_e64 v18, 1, v4
    v_lshl_add_u32 v21, v18, 6, v17
    v_xor_b32_e64 v18, 2, v4
    v_lshl_add_u32 v22, v18, 6, v17
    v_xor_b32_e64 v18, 3, v4
    v_lshl_add_u32 v23, v18, 6, v17
    v_mov_b32 v24, 0
    v_mov_b32 v25, 0
    v_mov_b32 v26, 0
    v_mov_b32 v27, 0
    v_mov_b32 v28, 0
    v_mov_b32 v29, 0
    v_mov_b32 v30, 0
    v_mov_b32 v31, 0
    s_mov_b32 s58, 0x3f803f80
    s_waitcnt vmcnt(4)
L_SC0:
    ds_read_b128 v[48:51], v19 offset:0
    ds_read_b128 v[52:55], v19 offset:1024
    ds_read_b128 v[56:59], v19 offset:2048
    ds_read_b128 v[60:63], v19 offset:3072
    s_waitcnt lgkmcnt(0)
    v_xor_b32 v48, s30, v49
    v_xor_b32 v50, s30, v51
    v_min_u32 v48, v48, v50
    v_xor_b32 v52, s30, v53
    v_xor_b32 v54, s30, v55
    v_min_u32 v52, v52, v54
    v_xor_b32 v56, s30, v57
    v_xor_b32 v58, s30, v59
    v_min_u32 v56, v56, v58
    v_xor_b32 v60, s30, v61
    v_xor_b32 v62, s30, v63
    v_min_u32 v60, v60, v62
    v_min_u32 v48, v48, v52
    v_min_u32 v48, v48, v56
    v_min_u32 v48, v48, v60
    v_cmp_eq_u32 vcc, 0, v48
    s_cbranch_vccz L_SC0_OK
    s_cmp_eq_u32 s19, 0
    s_cbranch_scc1 L_SC0_OK
    s_sub_u32 s19, s19, 1
    s_sleep 3
    s_add_u32 s59, s56, 0
    s_add_u32 m0, s57, 0
    s_nop 0
    buffer_load_dwordx4 v64, s[52:55], s59 offen sc1 lds
    s_add_u32 m0, s57, 1024
    s_nop 0
    buffer_load_dwordx4 v65, s[52:55], s59 offen sc1 lds
    s_add_u32 m0, s57, 2048
    s_nop 0
    buffer_load_dwordx4 v66, s[52:55], s59 offen sc1 lds
    s_add_u32 m0, s57, 3072
    s_nop 0
    buffer_load_dwordx4 v67, s[52:55], s59 offen sc1 lds
    s_waitcnt vmcnt(0)
    s_branch L_SC0
L_SC0_OK:
    ds_read_b64_tr_b16 v[32:33], v20 offset:0
    ds_read_b64_tr_b16 v[34:35], v20 offset:1024
    ds_read_b64_tr_b16 v[36:37], v21 offset:0
    ds_read_b64_tr_b16 v[38:39], v21 offset:1024
    ds_read_b64_tr_b16 v[40:41], v22 offset:0
    ds_read_b64_tr_b16 v[42:43], v22 offset:1024
    ds_read_b64_tr_b16 v[44:45], v23 offset:0
    ds_read_b64_tr_b16 v[46:47], v23 offset:1024
    s_waitcnt lgkmcnt(6)
    v_dot2_f32_bf16 v24, v32, s58, v24
    v_dot2_f32_bf16 v25, v32, v32, v25
    v_dot2_f32_bf16 v24, v33, s58, v24
    v_dot2_f32_bf16 v25, v33, v33, v25
    v_dot2_f32_bf16 v24, v34, s58, v24
    v_dot2_f32_bf16 v25, v34, v34, v25
    v_dot2_f32_bf16 v24, v35, s58, v24
    v_dot2_f32_bf16 v25, v35, v35, v25
    s_waitcnt lgkmcnt(4)
    s_nop 0
    v_dot2_f32_bf16 v26, v36, s58, v26
    v_dot2_f32_bf16 v27, v36, v36, v27
    v_dot2_f32_bf16 v26, v37, s58, v26
    v_dot2_f32_bf16 v27, v37, v37, v27
    v_dot2_f32_bf16 v26, v38, s58, v26
    v_dot2_f32_bf16 v27, v38, v38, v27
    v_dot2_f32_bf16 v26, v39, s58, v26
    v_dot2_f32_bf16 v27, v39, v39, v27
    s_waitcnt lgkmcnt(2)
    s_nop 0
    v_dot2_f32_bf16 v28, v40, s58, v28
    v_dot2_f32_bf16 v29, v40, v40, v29
    v_dot2_f32_bf16 v28, v41, s58, v28
    v_dot2_f32_bf16 v29, v41, v41, v29
    v_dot2_f32_bf16 v28, v42, s58, v28
    v_dot2_f32_bf16 v29, v42, v42, v29
    v_dot2_f32_bf16 v28, v43, s58, v28
    v_dot2_f32_bf16 v29, v43, v43, v29
    s_waitcnt lgkmcnt(0)
    s_nop 0
    v_dot2_f32_bf16 v30, v44, s58, v30
    v_dot2_f32_bf16 v31, v44, v44, v31
    v_dot2_f32_bf16 v30, v45, s58, v30
    v_dot2_f32_bf16 v31, v45, v45, v31
    v_dot2_f32_bf16 v30, v46, s58, v30
    v_dot2_f32_bf16 v31, v46, v46, v31
    v_dot2_f32_bf16 v30, v47, s58, v30
    v_dot2_f32_bf16 v31, v47, v47, v31
    s_waitcnt vmcnt(0)
L_SC1:
    ds_read_b128 v[48:51], v19 offset:4096
    ds_read_b128 v[52:55], v19 offset:5120
    ds_read_b128 v[56:59], v19 offset:6144
    ds_read_b128 v[60:63], v19 offset:7168
    s_waitcnt lgkmcnt(0)
    v_xor_b32 v48, s30, v49
    v_xor_b32 v50, s30, v51
    v_min_u32 v48, v48, v50
    v_xor_b32 v52, s30, v53
    v_xor_b32 v54, s30, v55
    v_min_u32 v52, v52, v54
    v_xor_b32 v56, s30, v57
    v_xor_b32 v58, s30, v59
    v_min_u32 v56, v56, v58
    v_xor_b32 v60, s30, v61
    v_xor_b32 v62, s30, v63
    v_min_u32 v60, v60, v62
    v_min_u32 v48, v48, v52
    v_min_u32 v48, v48, v56
    v_min_u32 v48, v48, v60
    v_cmp_eq_u32 vcc, 0, v48
    s_cbranch_vccz L_SC1_OK
    s_cmp_eq_u32 s19, 0
    s_cbranch_scc1 L_SC1_OK
    s_sub_u32 s19, s19, 1
    s_sleep 3
    s_add_u32 s59, s56, 0
    s_add_u32 m0, s57, 4096
    s_nop 0
    buffer_load_dwordx4 v68, s[52:55], s59 offen sc1 lds
    s_add_u32 m0, s57, 5120
    s_nop 0
    buffer_load_dwordx4 v69, s[52:55], s59 offen sc1 lds
    s_add_u32 m0, s57, 6144
    s_nop 0
    buffer_load_dwordx4 v70, s[52:55], s59 offen sc1 lds
    s_add_u32 m0, s57, 7168
    s_nop 0
    buffer_load_dwordx4 v71, s[52:55], s59 offen sc1 lds
    s_waitcnt vmcnt(0)
    s_branch L_SC1
L_SC1_OK:
    ds_read_b64_tr_b16 v[32:33], v20 offset:4096
    ds_read_b64_tr_b16 v[34:35], v20 offset:5120
    ds_read_b64_tr_b16 v[36:37], v21 offset:4096
    ds_read_b64_tr_b16 v[38:39], v21 offset:5120
    ds_read_b64_tr_b16 v[40:41], v22 offset:4096
    ds_read_b64_tr_b16 v[42:43], v22 offset:5120
    ds_read_b64_tr_b16 v[44:45], v23 offset:4096
    ds_read_b64_tr_b16 v[46:47], v23 offset:5120
    s_waitcnt lgkmcnt(6)
    s_nop 0
    v_dot2_f32_bf16 v24, v32, s58, v24
    v_dot2_f32_bf16 v25, v32, v32, v25
    v_dot2_f32_bf16 v24, v33, s58, v24
    v_dot2_f32_bf16 v25, v33, v33, v25
    v_dot2_f32_bf16 v24, v34, s58, v24
    v_dot2_f32_bf16 v25, v34, v34, v25
    v_dot2_f32_bf16 v24, v35, s58, v24
    v_dot2_f32_bf16 v25, v35, v35, v25
    s_waitcnt lgkmcnt(4)
    s_nop 0
    v_dot2_f32_bf16 v26, v36, s58, v26
    v_dot2_f32_bf16 v27, v36, v36, v27
    v_dot2_f32_bf16 v26, v37, s58, v26
    v_dot2_f32_bf16 v27, v37, v37, v27
    v_dot2_f32_bf16 v26, v38, s58, v26
    v_dot2_f32_bf16 v27, v38, v38, v27
    v_dot2_f32_bf16 v26, v39, s58, v26
    v_dot2_f32_bf16 v27, v39, v39, v27
    s_waitcnt lgkmcnt(2)
    s_nop 0
    v_dot2_f32_bf16 v28, v40, s58, v28
    v_dot2_f32_bf16 v29, v40, v40, v29
    v_dot2_f32_bf16 v28, v41, s58, v28
    v_dot2_f32_bf16 v29, v41, v41, v29
    v_dot2_f32_bf16 v28, v42, s58, v28
    v_dot2_f32_bf16 v29, v42, v42, v29
    v_dot2_f32_bf16 v28, v43, s58, v28
    v_dot2_f32_bf16 v29, v43, v43, v29
    s_waitcnt lgkmcnt(0)
    s_nop 0
    v_dot2_f32_bf16 v30, v44, s58, v30
    v_dot2_f32_bf16 v31, v44, v44, v31
    v_dot2_f32_bf16 v30, v45, s58, v30
    v_dot2_f32_bf16 v31, v45, v45, v31
    v_dot2_f32_bf16 v30, v46, s58, v30
    v_dot2_f32_bf16 v31, v46, v46, v31
    v_dot2_f32_bf16 v30, v47, s58, v30
    v_dot2_f32_bf16 v31, v47, v47, v31
    v_lshlrev_b32 v17, 3, v1
    v_add_u32 v17, s57, v17
    ds_write_b64 v17, v[24:25] offset:0
    ds_write_b64 v17, v[26:27] offset:512
    ds_write_b64 v17, v[28:29] offset:1024
    ds_write_b64 v17, v[30:31] offset:1536
    s_waitcnt lgkmcnt(0)
    s_barrier
    s_cmp_ge_u32 s3, 2
    s_cbranch_scc1 L_STATS_DONE
    v_lshrrev_b32 v16, 5, v0
    v_lshlrev_b32 v16, 9, v16
    v_and_b32_e64 v17, 31, v0
    v_lshl_add_u32 v16, v17, 3, v16
    v_add_u32 v17, 0x10000, v16
    ds_read_b64 v[32:33], v16 offset:0
    ds_read_b64 v[34:35], v16 offset:256
    ds_read_b64 v[36:37], v16 offset:16384
    ds_read_b64 v[38:39], v16 offset:16640
    ds_read_b64 v[40:41], v16 offset:32768
    ds_read_b64 v[42:43], v16 offset:33024
    ds_read_b64 v[44:45], v16 offset:49152
    ds_read_b64 v[46:47], v16 offset:49408
    ds_read_b64 v[48:49], v17 offset:0
    ds_read_b64 v[50:51], v17 offset:256
    ds_read_b64 v[52:53], v17 offset:16384
    ds_read_b64 v[54:55], v17 offset:16640
    ds_read_b64 v[56:57], v17 offset:32768
    ds_read_b64 v[58:59], v17 offset:33024
    ds_read_b64 v[60:61], v17 offset:49152
    ds_read_b64 v[62:63], v17 offset:49408
    s_waitcnt lgkmcnt(0)
    s_nop 0
    v_pk_add_f32 v[32:33], v[32:33], v[48:49]
    v_pk_add_f32 v[34:35], v[34:35], v[50:51]
    v_pk_add_f32 v[36:37], v[36:37], v[52:53]
    v_pk_add_f32 v[38:39], v[38:39], v[54:55]
    v_pk_add_f32 v[40:41], v[40:41], v[56:57]
    v_pk_add_f32 v[42:43], v[42:43], v[58:59]
    v_pk_add_f32 v[44:45], v[44:45], v[60:61]
    v_pk_add_f32 v[46:47], v[46:47], v[62:63]
    v_pk_add_f32 v[32:33], v[32:33], v[40:41]
    v_pk_add_f32 v[34:35], v[34:35], v[42:43]
    v_pk_add_f32 v[36:37], v[36:37], v[44:45]
    v_pk_add_f32 v[38:39], v[38:39], v[46:47]
    v_pk_add_f32 v[32:33], v[32:33], v[36:37]
    v_pk_add_f32 v[34:35], v[34:35], v[38:39]
    v_pk_add_f32 v[32:33], v[32:33], v[34:35]
    v_mov_b32 v34, v33
    v_mov_b32 v33, s30
    v_mov_b32 v35, s30
    v_lshlrev_b32 v16, 4, v0
    s_lshl_b32 s56, s6, 11
    s_add_u32 s56, s56, 294912
    buffer_store_dwordx4 v[32:35], v16, s[48:51], s56 offen sc1
L_STATS_DONE:
    s_barrier
    s_cmp_ge_u32 s3, 4
    s_cbranch_scc1 L_W2ALL
    s_branch L_HG2
L_END:
    s_endpgm
CODE_END:
    s_endpgm
.section .rodata,"a"
.p2align 6
.amdhsa_kernel sequential_preLN__ssm_conv_s4d__glu_gated_geglu__prompt_kernel
  .amdhsa_next_free_vgpr 256
  .amdhsa_next_free_sgpr 72
  .amdhsa_accum_offset 256
  .amdhsa_group_segment_fixed_size 0
  .amdhsa_kernarg_size 112
  .amdhsa_user_sgpr_count 2
  .amdhsa_user_sgpr_kernarg_segment_ptr 1
  .amdhsa_system_sgpr_workgroup_id_x 1
.end_amdhsa_kernel
```
